```python
import torch

def _softmax(x, axis=-1):
    return torch.softmax(x, dim=axis)
def _gelu(x):
    return torch.nn.functional.gelu(x, approximate="tanh")
def _silu(x):
    return torch.nn.functional.silu(x)
def _sigmoid(x):
    return torch.sigmoid(x)
def _layernorm(x, axis=-1, eps=1e-5):
    m = x.mean(dim=axis, keepdim=True)
    v = x.var(dim=axis, keepdim=True, unbiased=False)
    return (x - m) / torch.sqrt(v + eps)
def _scatter_add(tgt, idx, src, axis=0):
    return tgt.clone().index_add_(axis, idx, src)
def _segment_sum(src, seg, n):
    out = torch.zeros((n,) + src.shape[1:], dtype=src.dtype)
    return out.index_add_(0, seg, src)
def _pad(x, pw):
    flat = tuple(v for pair in reversed(pw) for v in pair)
    return torch.nn.functional.pad(x, flat)

kernel_name = 'standalone__linear_kernel_rfa__decode'

def setup_inputs():

    _w = (lambda a: (lambda t: t.to(torch.bfloat16) if t.is_floating_point() else t)(torch.as_tensor(a)))
    B, H, Sq, Sk, D, M = 1, 32, 1, 4096, 128, 64
    return {
        "q": _w((lambda *s: torch.randn(*s, dtype=torch.bfloat16) * 0.2)(B, H, Sq, D)),
        "k": _w((lambda *s: torch.randn(*s, dtype=torch.bfloat16) * 1.6)(B, H, Sk, D)),
        "v": _w((lambda *s: torch.randn(*s, dtype=torch.bfloat16) * 1.6)(B, H, Sk, D)),
        "omega": _w((lambda *s: torch.randn(*s, dtype=torch.bfloat16) * 1.6)(M, D)),
    }

def reference(q, k, v, omega):
    d = q.shape[-1]
    m = omega.shape[0]
    scale = float(d) ** -0.25
    qs = q * scale
    ks = k * scale
    q_proj = torch.einsum("bhsd,md->bhsm", qs, omega)
    k_proj = torch.einsum("bhsd,md->bhsm", ks, omega)
    q_sq = 0.5 * torch.einsum("bhsd,bhsd->bhs", qs, qs)[..., None]
    k_sq = 0.5 * torch.einsum("bhsd,bhsd->bhs", ks, ks)[..., None]
    inv_sqrt_m = float(m) ** -0.5
    phi_q = torch.exp(q_proj - q_sq) * inv_sqrt_m + 1e-6
    phi_k = torch.exp(k_proj - k_sq) * inv_sqrt_m + 1e-6
    kv = torch.einsum("bhsm,bhsd->bhmd", phi_k, v)
    z  = torch.einsum("bhsm->bhm", phi_k)
    num = torch.einsum("bhqm,bhmd->bhqd", phi_q, kv)
    den = torch.einsum("bhqm,bhm->bhq", phi_q, z)[..., None] + 1e-6
    return num / den
```

```asm
; @launch grid=(256,1,1) block=(512,1,1) lds=156928
.amdgcn_target "amdgcn-amd-amdhsa--gfx950"
.text
.globl standalone__linear_kernel_rfa__decode_kernel
.p2align 8
.type standalone__linear_kernel_rfa__decode_kernel,@function
standalone__linear_kernel_rfa__decode_kernel:
    s_cmp_ge_u32 s2, 256
    s_nop 0
    s_cbranch_scc1 L_end
    s_load_dwordx2 s[28:29], s[0:1], 24
    s_load_dwordx2 s[20:21], s[0:1], 8
    s_load_dwordx2 s[32:33], s[0:1], 0
    s_load_dwordx2 s[24:25], s[0:1], 16
    s_load_dwordx2 s[36:37], s[0:1], 48
    s_load_dwordx2 s[40:41], s[0:1], 40
    s_load_dwordx2 s[44:45], s[0:1], 32
    v_lshrrev_b32 v13, 6, v0
    v_and_b32 v1, 63, v0
    v_readfirstlane_b32 s50, v13
    v_lshrrev_b32 v2, 4, v1
    v_and_b32 v3, 15, v1
    s_and_b32 s48, s2, 31
    s_lshr_b32 s49, s2, 5
    s_mov_b32 s30, 0x4000
    s_mov_b32 s31, 0x00020000
    s_mov_b32 s22, 0x2000000
    s_mov_b32 s23, 0x00020000
    s_mov_b32 s34, 0x2000
    s_mov_b32 s35, 0x00020000
    s_mov_b32 s26, 0x2000000
    s_mov_b32 s27, 0x00020000
    s_mov_b32 s38, 0x100000
    s_mov_b32 s39, 0x00020000
    s_mov_b32 s42, 0x100
    s_mov_b32 s43, 0x00020000
    s_mov_b32 s46, 0x2000
    s_mov_b32 s47, 0x00020000
    v_xor_b32 v14, v2, v3
    v_lshlrev_b32 v14, 4, v14
    s_and_b32 s56, s50, 3
    s_mov_b32 s58, 0
    s_lshl_b32 s52, s56, 15
    s_add_u32 s59, s52, 16384
    s_lshl_b32 s61, s48, 3
    s_add_u32 s61, s61, s49
    s_lshl_b32 s61, s61, 10
    s_cmp_ge_u32 s50, 4
    s_nop 0
    s_cbranch_scc1 L_compute
    v_lshl_or_b32 v4, v2, 8, v14
    v_xor_b32 v5, 64, v4
    v_xor_b32 v6, 128, v4
    v_xor_b32 v7, 192, v4
    v_lshlrev_b32 v12, 4, v1
    v_lshlrev_b32 v19, 4, v1
    s_lshl_b32 s51, s48, 20
    s_bfe_u32 s53, s56, 0x10000
    s_lshl_b32 s53, s53, 12
    s_or_b32 s51, s51, s53
    s_bfe_u32 s53, s56, 0x10001
    s_lshl_b32 s53, s53, 13
    s_or_b32 s51, s51, s53
    s_bfe_u32 s53, s49, 0x10000
    s_lshl_b32 s53, s53, 17
    s_or_b32 s51, s51, s53
    s_bfe_u32 s53, s49, 0x10001
    s_lshl_b32 s53, s53, 18
    s_or_b32 s51, s51, s53
    s_bfe_u32 s53, s49, 0x10002
    s_lshl_b32 s53, s53, 19
    s_or_b32 s51, s51, s53
    s_lshl_b32 s54, s56, 12
    s_lshl_b32 s55, s48, 8
    s_lshl_b32 s57, s56, 4
    s_add_u32 s57, s57, 155712
    v_mov_b32 v13, s57
    s_waitcnt lgkmcnt(0)
    s_mov_b32 m0, s54
    s_nop 0
    buffer_load_dwordx4 v4, s[28:31], s54 offen lds
    buffer_load_dwordx4 v5, s[28:31], s54 offen offset:1024 lds
    buffer_load_dwordx4 v6, s[28:31], s54 offen offset:2048 lds
    buffer_load_dwordx4 v7, s[28:31], s54 offen offset:3072 lds
    s_cmp_lg_u32 s50, 0
    s_nop 0
    s_cbranch_scc1 L_noq
    s_mov_b32 m0, 155904
    s_nop 0
    buffer_load_dwordx4 v19, s[32:35], s55 offen lds
L_noq:
    s_mov_b32 s62, 0
    s_add_u32 s52, s59, 0
    s_mov_b32 m0, s52
    s_add_u32 s53, s51, 0
    buffer_load_dwordx4 v4, s[20:23], s53 offen nt lds
    buffer_load_dwordx4 v5, s[20:23], s53 offen offset:1024 nt lds
    buffer_load_dwordx4 v6, s[20:23], s53 offen offset:2048 nt lds
    buffer_load_dwordx4 v7, s[20:23], s53 offen offset:3072 nt lds
    s_add_u32 s52, s59, 4096
    s_mov_b32 m0, s52
    s_add_u32 s53, s51, 16384
    buffer_load_dwordx4 v4, s[20:23], s53 offen nt lds
    buffer_load_dwordx4 v5, s[20:23], s53 offen offset:1024 nt lds
    buffer_load_dwordx4 v6, s[20:23], s53 offen offset:2048 nt lds
    buffer_load_dwordx4 v7, s[20:23], s53 offen offset:3072 nt lds
    s_barrier
    s_add_u32 s52, s59, 8192
    s_mov_b32 m0, s52
    s_add_u32 s53, s51, 32768
    buffer_load_dwordx4 v4, s[20:23], s53 offen nt lds
    buffer_load_dwordx4 v5, s[20:23], s53 offen offset:1024 nt lds
    buffer_load_dwordx4 v6, s[20:23], s53 offen offset:2048 nt lds
    buffer_load_dwordx4 v7, s[20:23], s53 offen offset:3072 nt lds
    s_cmp_ge_i32 s62, 9
    s_nop 0
    s_cbranch_scc1 L_chk0
    s_getreg_b32 s54, hwreg(HW_REG_IB_STS)
    s_and_b32 s55, s54, 15
    s_bfe_u32 s54, s54, 0x20016
    s_lshl_b32 s54, s54, 4
    s_or_b32 s55, s55, s54
    s_sub_i32 s55, 16, s55
    s_ashr_i32 s55, s55, 2
    s_min_i32 s55, s55, 9
    s_cmp_le_i32 s55, s62
    s_nop 0
    s_cbranch_scc1 L_chk0
    s_mov_b32 s62, s55
    s_mov_b64 exec, 1
    v_mov_b32 v15, s62
    ds_write_b32 v13, v15
    s_mov_b64 exec, -1
    s_nop 0
L_chk0:
    s_add_u32 s52, s59, 12288
    s_mov_b32 m0, s52
    s_add_u32 s53, s51, 49152
    buffer_load_dwordx4 v4, s[20:23], s53 offen nt lds
    buffer_load_dwordx4 v5, s[20:23], s53 offen offset:1024 nt lds
    buffer_load_dwordx4 v6, s[20:23], s53 offen offset:2048 nt lds
    buffer_load_dwordx4 v7, s[20:23], s53 offen offset:3072 nt lds
    s_cmp_ge_i32 s62, 9
    s_nop 0
    s_cbranch_scc1 L_chk1
    s_getreg_b32 s54, hwreg(HW_REG_IB_STS)
    s_and_b32 s55, s54, 15
    s_bfe_u32 s54, s54, 0x20016
    s_lshl_b32 s54, s54, 4
    s_or_b32 s55, s55, s54
    s_sub_i32 s55, 20, s55
    s_ashr_i32 s55, s55, 2
    s_min_i32 s55, s55, 9
    s_cmp_le_i32 s55, s62
    s_nop 0
    s_cbranch_scc1 L_chk1
    s_mov_b32 s62, s55
    s_mov_b64 exec, 1
    v_mov_b32 v15, s62
    ds_write_b32 v13, v15
    s_mov_b64 exec, -1
    s_nop 0
L_chk1:
    s_add_u32 s52, s59, 16384
    s_mov_b32 m0, s52
    s_add_u32 s53, s51, 65536
    buffer_load_dwordx4 v4, s[20:23], s53 offen nt lds
    buffer_load_dwordx4 v5, s[20:23], s53 offen offset:1024 nt lds
    buffer_load_dwordx4 v6, s[20:23], s53 offen offset:2048 nt lds
    buffer_load_dwordx4 v7, s[20:23], s53 offen offset:3072 nt lds
    s_cmp_ge_i32 s62, 9
    s_nop 0
    s_cbranch_scc1 L_chk2
    s_getreg_b32 s54, hwreg(HW_REG_IB_STS)
    s_and_b32 s55, s54, 15
    s_bfe_u32 s54, s54, 0x20016
    s_lshl_b32 s54, s54, 4
    s_or_b32 s55, s55, s54
    s_sub_i32 s55, 24, s55
    s_ashr_i32 s55, s55, 2
    s_min_i32 s55, s55, 9
    s_cmp_le_i32 s55, s62
    s_nop 0
    s_cbranch_scc1 L_chk2
    s_mov_b32 s62, s55
    s_mov_b64 exec, 1
    v_mov_b32 v15, s62
    ds_write_b32 v13, v15
    s_mov_b64 exec, -1
    s_nop 0
L_chk2:
    s_add_u32 s52, s59, 20480
    s_mov_b32 m0, s52
    s_add_u32 s53, s51, 81920
    buffer_load_dwordx4 v4, s[20:23], s53 offen nt lds
    buffer_load_dwordx4 v5, s[20:23], s53 offen offset:1024 nt lds
    buffer_load_dwordx4 v6, s[20:23], s53 offen offset:2048 nt lds
    buffer_load_dwordx4 v7, s[20:23], s53 offen offset:3072 nt lds
    s_cmp_ge_i32 s62, 9
    s_nop 0
    s_cbranch_scc1 L_chk3
    s_getreg_b32 s54, hwreg(HW_REG_IB_STS)
    s_and_b32 s55, s54, 15
    s_bfe_u32 s54, s54, 0x20016
    s_lshl_b32 s54, s54, 4
    s_or_b32 s55, s55, s54
    s_sub_i32 s55, 28, s55
    s_ashr_i32 s55, s55, 2
    s_min_i32 s55, s55, 9
    s_cmp_le_i32 s55, s62
    s_nop 0
    s_cbranch_scc1 L_chk3
    s_mov_b32 s62, s55
    s_mov_b64 exec, 1
    v_mov_b32 v15, s62
    ds_write_b32 v13, v15
    s_mov_b64 exec, -1
    s_nop 0
L_chk3:
    s_add_u32 s52, s59, 24576
    s_mov_b32 m0, s52
    s_add_u32 s53, s51, 98304
    buffer_load_dwordx4 v4, s[20:23], s53 offen nt lds
    buffer_load_dwordx4 v5, s[20:23], s53 offen offset:1024 nt lds
    buffer_load_dwordx4 v6, s[20:23], s53 offen offset:2048 nt lds
    buffer_load_dwordx4 v7, s[20:23], s53 offen offset:3072 nt lds
    s_cmp_ge_i32 s62, 9
    s_nop 0
    s_cbranch_scc1 L_chk4
    s_getreg_b32 s54, hwreg(HW_REG_IB_STS)
    s_and_b32 s55, s54, 15
    s_bfe_u32 s54, s54, 0x20016
    s_lshl_b32 s54, s54, 4
    s_or_b32 s55, s55, s54
    s_sub_i32 s55, 32, s55
    s_ashr_i32 s55, s55, 2
    s_min_i32 s55, s55, 9
    s_cmp_le_i32 s55, s62
    s_nop 0
    s_cbranch_scc1 L_chk4
    s_mov_b32 s62, s55
    s_mov_b64 exec, 1
    v_mov_b32 v15, s62
    ds_write_b32 v13, v15
    s_mov_b64 exec, -1
    s_nop 0
L_chk4:
    s_add_u32 s52, s59, 28672
    s_mov_b32 m0, s52
    s_add_u32 s53, s51, 114688
    buffer_load_dwordx4 v4, s[20:23], s53 offen nt lds
    buffer_load_dwordx4 v5, s[20:23], s53 offen offset:1024 nt lds
    buffer_load_dwordx4 v6, s[20:23], s53 offen offset:2048 nt lds
    buffer_load_dwordx4 v7, s[20:23], s53 offen offset:3072 nt lds
    s_cmp_ge_i32 s62, 9
    s_nop 0
    s_cbranch_scc1 L_chk5
    s_getreg_b32 s54, hwreg(HW_REG_IB_STS)
    s_and_b32 s55, s54, 15
    s_bfe_u32 s54, s54, 0x20016
    s_lshl_b32 s54, s54, 4
    s_or_b32 s55, s55, s54
    s_sub_i32 s55, 36, s55
    s_ashr_i32 s55, s55, 2
    s_min_i32 s55, s55, 9
    s_cmp_le_i32 s55, s62
    s_nop 0
    s_cbranch_scc1 L_chk5
    s_mov_b32 s62, s55
    s_mov_b64 exec, 1
    v_mov_b32 v15, s62
    ds_write_b32 v13, v15
    s_mov_b64 exec, -1
    s_nop 0
L_chk5:
    s_add_u32 s53, s51, 0
    buffer_load_dwordx4 v[128:131], v12, s[24:27], s53 offen nt
    buffer_load_dwordx4 v[132:135], v12, s[24:27], s53 offen offset:1024 nt
    buffer_load_dwordx4 v[136:139], v12, s[24:27], s53 offen offset:2048 nt
    buffer_load_dwordx4 v[140:143], v12, s[24:27], s53 offen offset:3072 nt
    s_cmp_ge_i32 s62, 9
    s_nop 0
    s_cbranch_scc1 L_chk6
    s_getreg_b32 s54, hwreg(HW_REG_IB_STS)
    s_and_b32 s55, s54, 15
    s_bfe_u32 s54, s54, 0x20016
    s_lshl_b32 s54, s54, 4
    s_or_b32 s55, s55, s54
    s_sub_i32 s55, 40, s55
    s_ashr_i32 s55, s55, 2
    s_min_i32 s55, s55, 9
    s_cmp_le_i32 s55, s62
    s_nop 0
    s_cbranch_scc1 L_chk6
    s_mov_b32 s62, s55
    s_mov_b64 exec, 1
    v_mov_b32 v15, s62
    ds_write_b32 v13, v15
    s_mov_b64 exec, -1
    s_nop 0
L_chk6:
    s_add_u32 s53, s51, 16384
    buffer_load_dwordx4 v[144:147], v12, s[24:27], s53 offen nt
    buffer_load_dwordx4 v[148:151], v12, s[24:27], s53 offen offset:1024 nt
    buffer_load_dwordx4 v[152:155], v12, s[24:27], s53 offen offset:2048 nt
    buffer_load_dwordx4 v[156:159], v12, s[24:27], s53 offen offset:3072 nt
    s_cmp_ge_i32 s62, 9
    s_nop 0
    s_cbranch_scc1 L_chk7
    s_getreg_b32 s54, hwreg(HW_REG_IB_STS)
    s_and_b32 s55, s54, 15
    s_bfe_u32 s54, s54, 0x20016
    s_lshl_b32 s54, s54, 4
    s_or_b32 s55, s55, s54
    s_sub_i32 s55, 44, s55
    s_ashr_i32 s55, s55, 2
    s_min_i32 s55, s55, 9
    s_cmp_le_i32 s55, s62
    s_nop 0
    s_cbranch_scc1 L_chk7
    s_mov_b32 s62, s55
    s_mov_b64 exec, 1
    v_mov_b32 v15, s62
    ds_write_b32 v13, v15
    s_mov_b64 exec, -1
    s_nop 0
L_chk7:
    s_add_u32 s53, s51, 32768
    buffer_load_dwordx4 v[160:163], v12, s[24:27], s53 offen nt
    buffer_load_dwordx4 v[164:167], v12, s[24:27], s53 offen offset:1024 nt
    buffer_load_dwordx4 v[168:171], v12, s[24:27], s53 offen offset:2048 nt
    buffer_load_dwordx4 v[172:175], v12, s[24:27], s53 offen offset:3072 nt
    s_cmp_ge_i32 s62, 9
    s_nop 0
    s_cbranch_scc1 L_chk8
    s_getreg_b32 s54, hwreg(HW_REG_IB_STS)
    s_and_b32 s55, s54, 15
    s_bfe_u32 s54, s54, 0x20016
    s_lshl_b32 s54, s54, 4
    s_or_b32 s55, s55, s54
    s_sub_i32 s55, 48, s55
    s_ashr_i32 s55, s55, 2
    s_min_i32 s55, s55, 9
    s_cmp_le_i32 s55, s62
    s_nop 0
    s_cbranch_scc1 L_chk8
    s_mov_b32 s62, s55
    s_mov_b64 exec, 1
    v_mov_b32 v15, s62
    ds_write_b32 v13, v15
    s_mov_b64 exec, -1
    s_nop 0
L_chk8:
    s_add_u32 s53, s51, 49152
    buffer_load_dwordx4 v[176:179], v12, s[24:27], s53 offen nt
    buffer_load_dwordx4 v[180:183], v12, s[24:27], s53 offen offset:1024 nt
    buffer_load_dwordx4 v[184:187], v12, s[24:27], s53 offen offset:2048 nt
    buffer_load_dwordx4 v[188:191], v12, s[24:27], s53 offen offset:3072 nt
    s_cmp_ge_i32 s62, 9
    s_nop 0
    s_cbranch_scc1 L_chk9
    s_getreg_b32 s54, hwreg(HW_REG_IB_STS)
    s_and_b32 s55, s54, 15
    s_bfe_u32 s54, s54, 0x20016
    s_lshl_b32 s54, s54, 4
    s_or_b32 s55, s55, s54
    s_sub_i32 s55, 52, s55
    s_ashr_i32 s55, s55, 2
    s_min_i32 s55, s55, 9
    s_cmp_le_i32 s55, s62
    s_nop 0
    s_cbranch_scc1 L_chk9
    s_mov_b32 s62, s55
    s_mov_b64 exec, 1
    v_mov_b32 v15, s62
    ds_write_b32 v13, v15
    s_mov_b64 exec, -1
    s_nop 0
L_chk9:
    s_add_u32 s53, s51, 65536
    buffer_load_dwordx4 v[192:195], v12, s[24:27], s53 offen nt
    buffer_load_dwordx4 v[196:199], v12, s[24:27], s53 offen offset:1024 nt
    buffer_load_dwordx4 v[200:203], v12, s[24:27], s53 offen offset:2048 nt
    buffer_load_dwordx4 v[204:207], v12, s[24:27], s53 offen offset:3072 nt
    s_cmp_ge_i32 s62, 9
    s_nop 0
    s_cbranch_scc1 L_chk10
    s_getreg_b32 s54, hwreg(HW_REG_IB_STS)
    s_and_b32 s55, s54, 15
    s_bfe_u32 s54, s54, 0x20016
    s_lshl_b32 s54, s54, 4
    s_or_b32 s55, s55, s54
    s_sub_i32 s55, 56, s55
    s_ashr_i32 s55, s55, 2
    s_min_i32 s55, s55, 9
    s_cmp_le_i32 s55, s62
    s_nop 0
    s_cbranch_scc1 L_chk10
    s_mov_b32 s62, s55
    s_mov_b64 exec, 1
    v_mov_b32 v15, s62
    ds_write_b32 v13, v15
    s_mov_b64 exec, -1
    s_nop 0
L_chk10:
    s_add_u32 s53, s51, 81920
    buffer_load_dwordx4 v[208:211], v12, s[24:27], s53 offen nt
    buffer_load_dwordx4 v[212:215], v12, s[24:27], s53 offen offset:1024 nt
    buffer_load_dwordx4 v[216:219], v12, s[24:27], s53 offen offset:2048 nt
    buffer_load_dwordx4 v[220:223], v12, s[24:27], s53 offen offset:3072 nt
    s_cmp_ge_i32 s62, 9
    s_nop 0
    s_cbranch_scc1 L_chk11
    s_getreg_b32 s54, hwreg(HW_REG_IB_STS)
    s_and_b32 s55, s54, 15
    s_bfe_u32 s54, s54, 0x20016
    s_lshl_b32 s54, s54, 4
    s_or_b32 s55, s55, s54
    s_sub_i32 s55, 60, s55
    s_ashr_i32 s55, s55, 2
    s_min_i32 s55, s55, 9
    s_cmp_le_i32 s55, s62
    s_nop 0
    s_cbranch_scc1 L_chk11
    s_mov_b32 s62, s55
    s_mov_b64 exec, 1
    v_mov_b32 v15, s62
    ds_write_b32 v13, v15
    s_mov_b64 exec, -1
    s_nop 0
L_chk11:
    s_add_u32 s53, s51, 98304
    buffer_load_dwordx4 v[224:227], v12, s[24:27], s53 offen nt
    buffer_load_dwordx4 v[228:231], v12, s[24:27], s53 offen offset:1024 nt
    buffer_load_dwordx4 v[232:235], v12, s[24:27], s53 offen offset:2048 nt
    buffer_load_dwordx4 v[236:239], v12, s[24:27], s53 offen offset:3072 nt
    s_cmp_ge_i32 s62, 9
    s_nop 0
    s_cbranch_scc1 L_chk12
    s_getreg_b32 s54, hwreg(HW_REG_IB_STS)
    s_and_b32 s55, s54, 15
    s_bfe_u32 s54, s54, 0x20016
    s_lshl_b32 s54, s54, 4
    s_or_b32 s55, s55, s54
    s_sub_i32 s55, 64, s55
    s_ashr_i32 s55, s55, 2
    s_min_i32 s55, s55, 9
    s_cmp_le_i32 s55, s62
    s_nop 0
    s_cbranch_scc1 L_chk12
    s_mov_b32 s62, s55
    s_mov_b64 exec, 1
    v_mov_b32 v15, s62
    ds_write_b32 v13, v15
    s_mov_b64 exec, -1
    s_nop 0
L_chk12:
    s_add_u32 s53, s51, 114688
    buffer_load_dwordx4 v[240:243], v12, s[24:27], s53 offen nt
    buffer_load_dwordx4 v[244:247], v12, s[24:27], s53 offen offset:1024 nt
    buffer_load_dwordx4 v[248:251], v12, s[24:27], s53 offen offset:2048 nt
    buffer_load_dwordx4 v[252:255], v12, s[24:27], s53 offen offset:3072 nt
    s_cmp_ge_i32 s62, 9
    s_nop 0
    s_cbranch_scc1 L_chk13
    s_getreg_b32 s54, hwreg(HW_REG_IB_STS)
    s_and_b32 s55, s54, 15
    s_bfe_u32 s54, s54, 0x20016
    s_lshl_b32 s54, s54, 4
    s_or_b32 s55, s55, s54
    s_sub_i32 s55, 68, s55
    s_ashr_i32 s55, s55, 2
    s_min_i32 s55, s55, 9
    s_cmp_le_i32 s55, s62
    s_nop 0
    s_cbranch_scc1 L_chk13
    s_mov_b32 s62, s55
    s_mov_b64 exec, 1
    v_mov_b32 v15, s62
    ds_write_b32 v13, v15
    s_mov_b64 exec, -1
    s_nop 0
L_chk13:
L_drain:
    s_cmp_ge_i32 s62, 9
    s_nop 0
    s_cbranch_scc1 L_chk14
    s_getreg_b32 s54, hwreg(HW_REG_IB_STS)
    s_and_b32 s55, s54, 15
    s_bfe_u32 s54, s54, 0x20016
    s_lshl_b32 s54, s54, 4
    s_or_b32 s55, s55, s54
    s_sub_i32 s55, 68, s55
    s_ashr_i32 s55, s55, 2
    s_min_i32 s55, s55, 9
    s_cmp_le_i32 s55, s62
    s_nop 0
    s_cbranch_scc1 L_chk14
    s_mov_b32 s62, s55
    s_mov_b64 exec, 1
    v_mov_b32 v15, s62
    ds_write_b32 v13, v15
    s_mov_b64 exec, -1
    s_nop 0
L_chk14:
    s_cmp_ge_i32 s62, 9
    s_nop 0
    s_cbranch_scc0 L_drain
    v_and_b32 v8, 1, v3
    v_mov_b32 v9, 0xffff
    v_mov_b32 v10, 0xffff0000
    v_cmp_eq_u32 vcc, 1, v8
    s_nop 1
    v_cndmask_b32 v9, v9, v10, vcc
    v_bfe_u32 v8, v3, 1, 2
    v_cmp_eq_u32 vcc, 0, v8
    s_nop 1
    v_cndmask_b32 v20, 0, v9, vcc
    v_cmp_eq_u32 vcc, 1, v8
    s_nop 1
    v_cndmask_b32 v21, 0, v9, vcc
    v_cmp_eq_u32 vcc, 2, v8
    s_nop 1
    v_cndmask_b32 v22, 0, v9, vcc
    v_cmp_eq_u32 vcc, 3, v8
    s_nop 1
    v_cndmask_b32 v23, 0, v9, vcc
    s_lshl_b32 s52, s56, 10
    s_add_u32 s53, s52, 151552
    v_lshl_add_u32 v10, v3, 2, v2
    v_lshl_add_u32 v10, v10, 3, s53
    s_add_u32 s53, s52, 147456
    v_lshl_add_u32 v11, v1, 4, s53
    s_nop 1
L_wpoll:
    ds_read_b32 v8, v13 offset:8
    s_waitcnt lgkmcnt(0)
    v_readfirstlane_b32 s52, v8
    s_nop 3
    s_cmp_lg_u32 s52, 0
    s_nop 0
    s_cbranch_scc1 L_wready
    s_sleep 1
    s_add_u32 s58, s58, 1
    s_cmp_lt_u32 s58, 524288
    s_nop 0
    s_cbranch_scc1 L_wpoll
L_wready:
    ds_read_b64 v[24:25], v10
    ds_read_b64 v[26:27], v10 offset:512
    s_waitcnt lgkmcnt(0)
    v_mov_b32_dpp v48, v24 row_newbcast:0 row_mask:0xf bank_mask:0x3
    s_nop 1
    v_mov_b32_dpp v48, v25 row_newbcast:0 row_mask:0xf bank_mask:0xc
    v_and_b32 v32, v48, v20
    v_and_b32 v33, v48, v21
    v_and_b32 v34, v48, v22
    v_and_b32 v35, v48, v23
    v_mov_b32_dpp v49, v24 row_newbcast:1 row_mask:0xf bank_mask:0x3
    s_nop 1
    v_mov_b32_dpp v49, v25 row_newbcast:1 row_mask:0xf bank_mask:0xc
    v_and_b32 v36, v49, v20
    v_and_b32 v37, v49, v21
    v_and_b32 v38, v49, v22
    v_and_b32 v39, v49, v23
    v_mov_b32_dpp v50, v24 row_newbcast:2 row_mask:0xf bank_mask:0x3
    s_nop 1
    v_mov_b32_dpp v50, v25 row_newbcast:2 row_mask:0xf bank_mask:0xc
    v_and_b32 v40, v50, v20
    v_and_b32 v41, v50, v21
    v_and_b32 v42, v50, v22
    v_and_b32 v43, v50, v23
    s_waitcnt vmcnt(31)
    v_mfma_f32_16x16x32_bf16 v[16:19], v[128:131], v[32:35], 0
    v_mov_b32_dpp v51, v24 row_newbcast:3 row_mask:0xf bank_mask:0x3
    s_nop 1
    v_mov_b32_dpp v51, v25 row_newbcast:3 row_mask:0xf bank_mask:0xc
    v_and_b32 v44, v51, v20
    v_and_b32 v45, v51, v21
    v_and_b32 v46, v51, v22
    v_and_b32 v47, v51, v23
    s_waitcnt vmcnt(30)
    v_mfma_f32_16x16x32_bf16 v[16:19], v[132:135], v[36:39], v[16:19]
    v_mov_b32_dpp v48, v24 row_newbcast:4 row_mask:0xf bank_mask:0x3
    s_nop 1
    v_mov_b32_dpp v48, v25 row_newbcast:4 row_mask:0xf bank_mask:0xc
    v_and_b32 v32, v48, v20
    v_and_b32 v33, v48, v21
    v_and_b32 v34, v48, v22
    v_and_b32 v35, v48, v23
    s_waitcnt vmcnt(29)
    v_mfma_f32_16x16x32_bf16 v[16:19], v[136:139], v[40:43], v[16:19]
    v_mov_b32_dpp v49, v24 row_newbcast:5 row_mask:0xf bank_mask:0x3
    s_nop 1
    v_mov_b32_dpp v49, v25 row_newbcast:5 row_mask:0xf bank_mask:0xc
    v_and_b32 v36, v49, v20
    v_and_b32 v37, v49, v21
    v_and_b32 v38, v49, v22
    v_and_b32 v39, v49, v23
    s_waitcnt vmcnt(28)
    v_mfma_f32_16x16x32_bf16 v[16:19], v[140:143], v[44:47], v[16:19]
    v_mov_b32_dpp v50, v24 row_newbcast:6 row_mask:0xf bank_mask:0x3
    s_nop 1
    v_mov_b32_dpp v50, v25 row_newbcast:6 row_mask:0xf bank_mask:0xc
    v_and_b32 v40, v50, v20
    v_and_b32 v41, v50, v21
    v_and_b32 v42, v50, v22
    v_and_b32 v43, v50, v23
    s_waitcnt vmcnt(27)
    v_mfma_f32_16x16x32_bf16 v[16:19], v[144:147], v[32:35], v[16:19]
    v_mov_b32_dpp v51, v24 row_newbcast:7 row_mask:0xf bank_mask:0x3
    s_nop 1
    v_mov_b32_dpp v51, v25 row_newbcast:7 row_mask:0xf bank_mask:0xc
    v_and_b32 v44, v51, v20
    v_and_b32 v45, v51, v21
    v_and_b32 v46, v51, v22
    v_and_b32 v47, v51, v23
    s_waitcnt vmcnt(26)
    v_mfma_f32_16x16x32_bf16 v[16:19], v[148:151], v[36:39], v[16:19]
    v_mov_b32_dpp v48, v24 row_newbcast:8 row_mask:0xf bank_mask:0x3
    s_nop 1
    v_mov_b32_dpp v48, v25 row_newbcast:8 row_mask:0xf bank_mask:0xc
    v_and_b32 v32, v48, v20
    v_and_b32 v33, v48, v21
    v_and_b32 v34, v48, v22
    v_and_b32 v35, v48, v23
    s_waitcnt vmcnt(25)
    v_mfma_f32_16x16x32_bf16 v[16:19], v[152:155], v[40:43], v[16:19]
    v_mov_b32_dpp v49, v24 row_newbcast:9 row_mask:0xf bank_mask:0x3
    s_nop 1
    v_mov_b32_dpp v49, v25 row_newbcast:9 row_mask:0xf bank_mask:0xc
    v_and_b32 v36, v49, v20
    v_and_b32 v37, v49, v21
    v_and_b32 v38, v49, v22
    v_and_b32 v39, v49, v23
    s_waitcnt vmcnt(24)
    v_mfma_f32_16x16x32_bf16 v[16:19], v[156:159], v[44:47], v[16:19]
    v_mov_b32_dpp v50, v24 row_newbcast:10 row_mask:0xf bank_mask:0x3
    s_nop 1
    v_mov_b32_dpp v50, v25 row_newbcast:10 row_mask:0xf bank_mask:0xc
    v_and_b32 v40, v50, v20
    v_and_b32 v41, v50, v21
    v_and_b32 v42, v50, v22
    v_and_b32 v43, v50, v23
    s_waitcnt vmcnt(23)
    v_mfma_f32_16x16x32_bf16 v[16:19], v[160:163], v[32:35], v[16:19]
    v_mov_b32_dpp v51, v24 row_newbcast:11 row_mask:0xf bank_mask:0x3
    s_nop 1
    v_mov_b32_dpp v51, v25 row_newbcast:11 row_mask:0xf bank_mask:0xc
    v_and_b32 v44, v51, v20
    v_and_b32 v45, v51, v21
    v_and_b32 v46, v51, v22
    v_and_b32 v47, v51, v23
    s_waitcnt vmcnt(22)
    v_mfma_f32_16x16x32_bf16 v[16:19], v[164:167], v[36:39], v[16:19]
    v_mov_b32_dpp v48, v24 row_newbcast:12 row_mask:0xf bank_mask:0x3
    s_nop 1
    v_mov_b32_dpp v48, v25 row_newbcast:12 row_mask:0xf bank_mask:0xc
    v_and_b32 v32, v48, v20
    v_and_b32 v33, v48, v21
    v_and_b32 v34, v48, v22
    v_and_b32 v35, v48, v23
    s_waitcnt vmcnt(21)
    v_mfma_f32_16x16x32_bf16 v[16:19], v[168:171], v[40:43], v[16:19]
    v_mov_b32_dpp v49, v24 row_newbcast:13 row_mask:0xf bank_mask:0x3
    s_nop 1
    v_mov_b32_dpp v49, v25 row_newbcast:13 row_mask:0xf bank_mask:0xc
    v_and_b32 v36, v49, v20
    v_and_b32 v37, v49, v21
    v_and_b32 v38, v49, v22
    v_and_b32 v39, v49, v23
    s_waitcnt vmcnt(20)
    v_mfma_f32_16x16x32_bf16 v[16:19], v[172:175], v[44:47], v[16:19]
    v_mov_b32_dpp v50, v24 row_newbcast:14 row_mask:0xf bank_mask:0x3
    s_nop 1
    v_mov_b32_dpp v50, v25 row_newbcast:14 row_mask:0xf bank_mask:0xc
    v_and_b32 v40, v50, v20
    v_and_b32 v41, v50, v21
    v_and_b32 v42, v50, v22
    v_and_b32 v43, v50, v23
    s_waitcnt vmcnt(19)
    v_mfma_f32_16x16x32_bf16 v[16:19], v[176:179], v[32:35], v[16:19]
    v_mov_b32_dpp v51, v24 row_newbcast:15 row_mask:0xf bank_mask:0x3
    s_nop 1
    v_mov_b32_dpp v51, v25 row_newbcast:15 row_mask:0xf bank_mask:0xc
    v_and_b32 v44, v51, v20
    v_and_b32 v45, v51, v21
    v_and_b32 v46, v51, v22
    v_and_b32 v47, v51, v23
    s_waitcnt vmcnt(18)
    v_mfma_f32_16x16x32_bf16 v[16:19], v[180:183], v[36:39], v[16:19]
    v_mov_b32_dpp v48, v26 row_newbcast:0 row_mask:0xf bank_mask:0x3
    s_nop 1
    v_mov_b32_dpp v48, v27 row_newbcast:0 row_mask:0xf bank_mask:0xc
    v_and_b32 v32, v48, v20
    v_and_b32 v33, v48, v21
    v_and_b32 v34, v48, v22
    v_and_b32 v35, v48, v23
    s_waitcnt vmcnt(17)
    v_mfma_f32_16x16x32_bf16 v[16:19], v[184:187], v[40:43], v[16:19]
    v_mov_b32_dpp v49, v26 row_newbcast:1 row_mask:0xf bank_mask:0x3
    s_nop 1
    v_mov_b32_dpp v49, v27 row_newbcast:1 row_mask:0xf bank_mask:0xc
    v_and_b32 v36, v49, v20
    v_and_b32 v37, v49, v21
    v_and_b32 v38, v49, v22
    v_and_b32 v39, v49, v23
    s_waitcnt vmcnt(16)
    v_mfma_f32_16x16x32_bf16 v[16:19], v[188:191], v[44:47], v[16:19]
    v_mov_b32_dpp v50, v26 row_newbcast:2 row_mask:0xf bank_mask:0x3
    s_nop 1
    v_mov_b32_dpp v50, v27 row_newbcast:2 row_mask:0xf bank_mask:0xc
    v_and_b32 v40, v50, v20
    v_and_b32 v41, v50, v21
    v_and_b32 v42, v50, v22
    v_and_b32 v43, v50, v23
    s_waitcnt vmcnt(15)
    v_mfma_f32_16x16x32_bf16 v[16:19], v[192:195], v[32:35], v[16:19]
    v_mov_b32_dpp v51, v26 row_newbcast:3 row_mask:0xf bank_mask:0x3
    s_nop 1
    v_mov_b32_dpp v51, v27 row_newbcast:3 row_mask:0xf bank_mask:0xc
    v_and_b32 v44, v51, v20
    v_and_b32 v45, v51, v21
    v_and_b32 v46, v51, v22
    v_and_b32 v47, v51, v23
    s_waitcnt vmcnt(14)
    v_mfma_f32_16x16x32_bf16 v[16:19], v[196:199], v[36:39], v[16:19]
    v_mov_b32_dpp v48, v26 row_newbcast:4 row_mask:0xf bank_mask:0x3
    s_nop 1
    v_mov_b32_dpp v48, v27 row_newbcast:4 row_mask:0xf bank_mask:0xc
    v_and_b32 v32, v48, v20
    v_and_b32 v33, v48, v21
    v_and_b32 v34, v48, v22
    v_and_b32 v35, v48, v23
    s_waitcnt vmcnt(13)
    v_mfma_f32_16x16x32_bf16 v[16:19], v[200:203], v[40:43], v[16:19]
    v_mov_b32_dpp v49, v26 row_newbcast:5 row_mask:0xf bank_mask:0x3
    s_nop 1
    v_mov_b32_dpp v49, v27 row_newbcast:5 row_mask:0xf bank_mask:0xc
    v_and_b32 v36, v49, v20
    v_and_b32 v37, v49, v21
    v_and_b32 v38, v49, v22
    v_and_b32 v39, v49, v23
    s_waitcnt vmcnt(12)
    v_mfma_f32_16x16x32_bf16 v[16:19], v[204:207], v[44:47], v[16:19]
    v_mov_b32_dpp v50, v26 row_newbcast:6 row_mask:0xf bank_mask:0x3
    s_nop 1
    v_mov_b32_dpp v50, v27 row_newbcast:6 row_mask:0xf bank_mask:0xc
    v_and_b32 v40, v50, v20
    v_and_b32 v41, v50, v21
    v_and_b32 v42, v50, v22
    v_and_b32 v43, v50, v23
    s_waitcnt vmcnt(11)
    v_mfma_f32_16x16x32_bf16 v[16:19], v[208:211], v[32:35], v[16:19]
    v_mov_b32_dpp v51, v26 row_newbcast:7 row_mask:0xf bank_mask:0x3
    s_nop 1
    v_mov_b32_dpp v51, v27 row_newbcast:7 row_mask:0xf bank_mask:0xc
    v_and_b32 v44, v51, v20
    v_and_b32 v45, v51, v21
    v_and_b32 v46, v51, v22
    v_and_b32 v47, v51, v23
    s_waitcnt vmcnt(10)
    v_mfma_f32_16x16x32_bf16 v[16:19], v[212:215], v[36:39], v[16:19]
    v_mov_b32_dpp v48, v26 row_newbcast:8 row_mask:0xf bank_mask:0x3
    s_nop 1
    v_mov_b32_dpp v48, v27 row_newbcast:8 row_mask:0xf bank_mask:0xc
    v_and_b32 v32, v48, v20
    v_and_b32 v33, v48, v21
    v_and_b32 v34, v48, v22
    v_and_b32 v35, v48, v23
    s_waitcnt vmcnt(9)
    v_mfma_f32_16x16x32_bf16 v[16:19], v[216:219], v[40:43], v[16:19]
    v_mov_b32_dpp v49, v26 row_newbcast:9 row_mask:0xf bank_mask:0x3
    s_nop 1
    v_mov_b32_dpp v49, v27 row_newbcast:9 row_mask:0xf bank_mask:0xc
    v_and_b32 v36, v49, v20
    v_and_b32 v37, v49, v21
    v_and_b32 v38, v49, v22
    v_and_b32 v39, v49, v23
    s_waitcnt vmcnt(8)
    v_mfma_f32_16x16x32_bf16 v[16:19], v[220:223], v[44:47], v[16:19]
    v_mov_b32_dpp v50, v26 row_newbcast:10 row_mask:0xf bank_mask:0x3
    s_nop 1
    v_mov_b32_dpp v50, v27 row_newbcast:10 row_mask:0xf bank_mask:0xc
    v_and_b32 v40, v50, v20
    v_and_b32 v41, v50, v21
    v_and_b32 v42, v50, v22
    v_and_b32 v43, v50, v23
    s_waitcnt vmcnt(7)
    v_mfma_f32_16x16x32_bf16 v[16:19], v[224:227], v[32:35], v[16:19]
    v_mov_b32_dpp v51, v26 row_newbcast:11 row_mask:0xf bank_mask:0x3
    s_nop 1
    v_mov_b32_dpp v51, v27 row_newbcast:11 row_mask:0xf bank_mask:0xc
    v_and_b32 v44, v51, v20
    v_and_b32 v45, v51, v21
    v_and_b32 v46, v51, v22
    v_and_b32 v47, v51, v23
    s_waitcnt vmcnt(6)
    v_mfma_f32_16x16x32_bf16 v[16:19], v[228:231], v[36:39], v[16:19]
    v_mov_b32_dpp v48, v26 row_newbcast:12 row_mask:0xf bank_mask:0x3
    s_nop 1
    v_mov_b32_dpp v48, v27 row_newbcast:12 row_mask:0xf bank_mask:0xc
    v_and_b32 v32, v48, v20
    v_and_b32 v33, v48, v21
    v_and_b32 v34, v48, v22
    v_and_b32 v35, v48, v23
    s_waitcnt vmcnt(5)
    v_mfma_f32_16x16x32_bf16 v[16:19], v[232:235], v[40:43], v[16:19]
    v_mov_b32_dpp v49, v26 row_newbcast:13 row_mask:0xf bank_mask:0x3
    s_nop 1
    v_mov_b32_dpp v49, v27 row_newbcast:13 row_mask:0xf bank_mask:0xc
    v_and_b32 v36, v49, v20
    v_and_b32 v37, v49, v21
    v_and_b32 v38, v49, v22
    v_and_b32 v39, v49, v23
    s_waitcnt vmcnt(4)
    v_mfma_f32_16x16x32_bf16 v[16:19], v[236:239], v[44:47], v[16:19]
    v_mov_b32_dpp v50, v26 row_newbcast:14 row_mask:0xf bank_mask:0x3
    s_nop 1
    v_mov_b32_dpp v50, v27 row_newbcast:14 row_mask:0xf bank_mask:0xc
    v_and_b32 v40, v50, v20
    v_and_b32 v41, v50, v21
    v_and_b32 v42, v50, v22
    v_and_b32 v43, v50, v23
    s_waitcnt vmcnt(3)
    v_mfma_f32_16x16x32_bf16 v[16:19], v[240:243], v[32:35], v[16:19]
    v_mov_b32_dpp v51, v26 row_newbcast:15 row_mask:0xf bank_mask:0x3
    s_nop 1
    v_mov_b32_dpp v51, v27 row_newbcast:15 row_mask:0xf bank_mask:0xc
    v_and_b32 v44, v51, v20
    v_and_b32 v45, v51, v21
    v_and_b32 v46, v51, v22
    v_and_b32 v47, v51, v23
    s_waitcnt vmcnt(2)
    v_mfma_f32_16x16x32_bf16 v[16:19], v[244:247], v[36:39], v[16:19]
    s_waitcnt vmcnt(1)
    v_mfma_f32_16x16x32_bf16 v[16:19], v[248:251], v[40:43], v[16:19]
    s_waitcnt vmcnt(0)
    v_mfma_f32_16x16x32_bf16 v[16:19], v[252:255], v[44:47], v[16:19]
    s_nop 7
    ds_write_b128 v11, v[16:19]
    s_waitcnt lgkmcnt(0)
    s_mov_b64 exec, 1
    v_mov_b32 v15, 1
    ds_write_b32 v13, v15 offset:12
    s_mov_b64 exec, -1
    s_nop 0
    s_branch L_end_l
L_compute:
    s_setprio 2
    s_cmp_eq_u32 s50, 4
    s_cselect_b32 s60, s49, 0
    v_mov_b32 v60, -1
    v_mov_b32 v61, -1
    v_mov_b32 v62, -1
    v_mov_b32 v63, -1
    v_lshlrev_b32 v19, 4, v1
    v_mov_b32 v56, 0
    v_mov_b32 v57, 0
    v_mov_b32 v58, 0
    v_mov_b32 v59, 0
    s_lshl_b32 s57, s56, 4
    s_add_u32 s57, s57, 155712
    v_mov_b32 v12, s57
    s_mov_b64 exec, 1
    ds_write_b128 v12, v[56:59]
    s_mov_b64 exec, -1
    s_waitcnt lgkmcnt(0)
    s_cmp_eq_u32 s60, 0
    s_nop 0
    s_cbranch_scc1 L_noclear
    buffer_store_dwordx4 v[60:63], v19, s[36:39], s61 offen sc1
    s_nop 1
L_noclear:
    s_barrier
    v_lshl_or_b32 v4, v3, 8, v14
    v_xor_b32 v5, 64, v4
    v_xor_b32 v6, 128, v4
    v_xor_b32 v7, 192, v4
    v_mov_b32 v26, 0xffff0000
    v_mov_b32 v27, 0x3fb8aa3b
    v_lshrrev_b32 v52, 2, v3
    v_and_b32 v53, 3, v3
    v_and_b32 v54, 1, v3
    v_mov_b32 v55, 0xffff
    v_cmp_eq_u32 vcc, 1, v54
    s_nop 1
    v_cndmask_b32 v55, v55, v26, vcc
    v_cmp_eq_u32 vcc, v2, v52
    s_nop 1
    v_cndmask_b32 v55, 0, v55, vcc
    v_cmp_gt_u32 vcc, 2, v53
    s_nop 1
    v_cndmask_b32 v20, 0, v55, vcc
    v_cndmask_b32 v21, v55, 0, vcc
    v_and_b32 v24, 0x3f803f80, v20
    v_and_b32 v25, 0x3f803f80, v21
    v_and_b32 v180, 0x3e003e00, v20
    v_and_b32 v181, 0x3e003e00, v21
    v_and_b32 v28, 0x3e983e98, v20
    v_and_b32 v29, 0x3e983e98, v21
    v_and_b32 v30, 0x39e039e0, v20
    v_and_b32 v31, 0x39e039e0, v21
    v_mov_b32 v22, 0xbf00bf00
    v_mov_b32 v23, 0xbf00bf00
    v_mov_b32 v184, 0x35860000
    v_mov_b32 v185, 0x35860000
    v_mov_b32 v186, 0x35860000
    v_mov_b32 v187, 0x35860000
    v_lshlrev_b32 v13, 4, v2
    v_add_u32 v13, 155904, v13
    v_and_b32 v182, 3, v1
    v_lshlrev_b32 v182, 4, v182
    v_add_u32 v182, 155712, v182
    v_add_u32 v8, s59, v4
    v_add_u32 v9, s59, v5
    v_add_u32 v10, s59, v6
    v_add_u32 v11, s59, v7
    s_nop 1
L_ompoll:
    ds_read_b32 v183, v182
    s_waitcnt lgkmcnt(0)
    v_cmp_eq_u32 vcc, 0, v183
    s_nop 4
    s_cbranch_vccz L_omready
    s_sleep 1
    s_add_u32 s58, s58, 1
    s_cmp_lt_u32 s58, 524288
    s_nop 0
    s_cbranch_scc1 L_ompoll
L_omready:
    ds_read2_b64 v[148:151], v13 offset0:0 offset1:0
    ds_read2_b64 v[152:155], v13 offset0:1 offset1:1
    ds_read2_b64 v[156:159], v13 offset0:8 offset1:8
    ds_read2_b64 v[160:163], v13 offset0:9 offset1:9
    ds_read2_b64 v[164:167], v13 offset0:16 offset1:16
    ds_read2_b64 v[168:171], v13 offset0:17 offset1:17
    ds_read2_b64 v[172:175], v13 offset0:24 offset1:24
    ds_read2_b64 v[176:179], v13 offset0:25 offset1:25
    ds_read_b128 v[192:195], v4
    ds_read_b128 v[196:199], v5
    ds_read_b128 v[200:203], v6
    ds_read_b128 v[204:207], v7
    ds_read_b128 v[208:211], v4 offset:4096
    ds_read_b128 v[212:215], v5 offset:4096
    ds_read_b128 v[216:219], v6 offset:4096
    ds_read_b128 v[220:223], v7 offset:4096
    ds_read_b128 v[224:227], v4 offset:8192
    ds_read_b128 v[228:231], v5 offset:8192
    ds_read_b128 v[232:235], v6 offset:8192
    ds_read_b128 v[236:239], v7 offset:8192
    ds_read_b128 v[240:243], v4 offset:12288
    ds_read_b128 v[244:247], v5 offset:12288
    ds_read_b128 v[248:251], v6 offset:12288
    ds_read_b128 v[252:255], v7 offset:12288
    v_mov_b32 v4, v8
    v_add_u32 v8, 8, v8
    v_mov_b32 v5, v9
    v_add_u32 v9, 8, v9
    v_mov_b32 v6, v10
    v_add_u32 v10, 8, v10
    v_mov_b32 v7, v11
    v_add_u32 v11, 8, v11
    s_waitcnt lgkmcnt(0)
    v_mfma_f32_16x16x32_bf16 v[72:75], v[28:31], v[148:151], 0
    v_mfma_f32_16x16x32_bf16 v[76:79], v[28:31], v[152:155], 0
    v_mfma_f32_16x16x32_bf16 v[80:83], v[28:31], v[156:159], 0
    s_nop 5
    v_cvt_pk_bf16_f32 v84, v72, v73
    v_cvt_pk_bf16_f32 v85, v74, v75
    v_cvt_pk_bf16_f32 v86, v76, v77
    v_cvt_pk_bf16_f32 v87, v78, v79
    v_mfma_f32_16x16x32_bf16 v[72:75], v[28:31], v[160:163], 0
    v_cvt_pk_bf16_f32 v88, v80, v81
    v_cvt_pk_bf16_f32 v89, v82, v83
    v_mfma_f32_16x16x32_bf16 v[76:79], v[28:31], v[164:167], 0
    v_mfma_f32_16x16x32_bf16 v[80:83], v[28:31], v[168:171], 0
    v_mfma_f32_16x16x32_bf16 v[68:71], v[84:87], v[84:87], 0
    s_nop 2
    v_cvt_pk_bf16_f32 v90, v72, v73
    v_cvt_pk_bf16_f32 v91, v74, v75
    v_mfma_f32_16x16x32_bf16 v[72:75], v[28:31], v[172:175], 0
    v_cvt_pk_bf16_f32 v92, v76, v77
    v_cvt_pk_bf16_f32 v93, v78, v79
    v_cvt_pk_bf16_f32 v94, v80, v81
    v_mfma_f32_16x16x32_bf16 v[76:79], v[28:31], v[176:179], 0
    v_cvt_pk_bf16_f32 v95, v82, v83
    v_mfma_f32_16x16x32_bf16 v[132:135], v[192:195], v[84:87], 0
    s_nop 1
    v_cvt_pk_bf16_f32 v96, v72, v73
    v_mfma_f32_16x16x32_bf16 v[136:139], v[208:211], v[84:87], 0
    v_cvt_pk_bf16_f32 v97, v74, v75
    s_nop 0
    v_cvt_pk_bf16_f32 v98, v76, v77
    v_mfma_f32_16x16x32_bf16 v[140:143], v[224:227], v[84:87], 0
    v_cvt_pk_bf16_f32 v99, v78, v79
    v_mfma_f32_16x16x32_bf16 v[144:147], v[240:243], v[84:87], 0
    v_mfma_f32_16x16x32_bf16 v[68:71], v[88:91], v[88:91], v[68:71]
    v_mfma_f32_16x16x32_bf16 v[132:135], v[196:199], v[88:91], v[132:135]
    v_mfma_f32_16x16x32_bf16 v[136:139], v[212:215], v[88:91], v[136:139]
    v_mfma_f32_16x16x32_bf16 v[140:143], v[228:231], v[88:91], v[140:143]
    v_mfma_f32_16x16x32_bf16 v[144:147], v[244:247], v[88:91], v[144:147]
    v_mfma_f32_16x16x32_bf16 v[68:71], v[92:95], v[92:95], v[68:71]
    v_mfma_f32_16x16x32_bf16 v[132:135], v[200:203], v[92:95], v[132:135]
    v_mfma_f32_16x16x32_bf16 v[136:139], v[216:219], v[92:95], v[136:139]
    v_mfma_f32_16x16x32_bf16 v[140:143], v[232:235], v[92:95], v[140:143]
    v_mfma_f32_16x16x32_bf16 v[144:147], v[248:251], v[92:95], v[144:147]
    v_mfma_f32_16x16x32_bf16 v[68:71], v[96:99], v[96:99], v[68:71]
    v_mfma_f32_16x16x32_bf16 v[132:135], v[204:207], v[96:99], v[132:135]
    v_mfma_f32_16x16x32_bf16 v[136:139], v[220:223], v[96:99], v[136:139]
    v_mfma_f32_16x16x32_bf16 v[140:143], v[236:239], v[96:99], v[140:143]
    v_mfma_f32_16x16x32_bf16 v[144:147], v[252:255], v[96:99], v[144:147]
    s_nop 7
L_kpoll0:
    ds_read_b32 v183, v12
    s_waitcnt lgkmcnt(0)
    v_readfirstlane_b32 s52, v183
    s_nop 3
    s_cmp_gt_u32 s52, 1
    s_nop 0
    s_cbranch_scc1 L_kready0
    s_sleep 1
    s_add_u32 s58, s58, 1
    s_cmp_lt_u32 s58, 524288
    s_nop 0
    s_cbranch_scc1 L_kpoll0
L_kready0:
    ds_read2st64_b64 v[148:151], v4 offset0:0 offset1:0
    ds_read2st64_b64 v[152:155], v8 offset0:0 offset1:0
    ds_read2st64_b64 v[156:159], v5 offset0:0 offset1:0
    ds_read2st64_b64 v[160:163], v9 offset0:0 offset1:0
    ds_read2st64_b64 v[164:167], v6 offset0:0 offset1:0
    ds_read2st64_b64 v[168:171], v10 offset0:0 offset1:0
    ds_read2st64_b64 v[172:175], v7 offset0:0 offset1:0
    ds_read2st64_b64 v[176:179], v11 offset0:0 offset1:0
    v_cvt_pk_bf16_f32 v52, v68, v69
    v_cvt_pk_bf16_f32 v53, v70, v71
    v_and_b32 v52, v52, v20
    v_and_b32 v53, v53, v21
    v_cvt_pk_bf16_f32 v32, v132, v133
    v_cvt_pk_bf16_f32 v33, v134, v135
    v_mfma_f32_16x16x16_bf16 v[48:51], v[22:23], v[52:53], 0
    v_cvt_pk_bf16_f32 v34, v136, v137
    v_cvt_pk_bf16_f32 v35, v138, v139
    v_cvt_pk_bf16_f32 v36, v140, v141
    v_mfma_f32_16x16x16_bf16 v[100:103], v[24:25], v[32:33], v[48:51]
    v_cvt_pk_bf16_f32 v37, v142, v143
    v_cvt_pk_bf16_f32 v38, v144, v145
    v_cvt_pk_bf16_f32 v39, v146, v147
    v_mfma_f32_16x16x16_bf16 v[104:107], v[24:25], v[34:35], v[48:51]
    s_waitcnt lgkmcnt(0)
    v_mov_b32 v54, 0x35860000
    v_mfma_f32_16x16x16_bf16 v[108:111], v[24:25], v[36:37], v[48:51]
    s_nop 0
    v_cvt_pk_bf16_f32 v32, v100, v101
    v_cvt_pk_bf16_f32 v33, v102, v103
    v_mfma_f32_16x16x16_bf16 v[112:115], v[24:25], v[38:39], v[48:51]
    v_lshlrev_b32 v132, 16, v32
    v_cvt_pk_bf16_f32 v34, v104, v105
    v_cvt_pk_bf16_f32 v35, v106, v107
    v_mfma_f32_16x16x32_bf16 v[72:75], v[28:31], v[148:151], 0
    v_and_b32 v133, v26, v32
    v_lshlrev_b32 v134, 16, v33
    v_and_b32 v135, v26, v33
    v_mfma_f32_16x16x32_bf16 v[76:79], v[28:31], v[152:155], 0
    v_mul_f32 v132, v27, v132
    v_mul_f32 v133, v27, v133
    v_mul_f32 v134, v27, v134
    v_mul_f32 v135, v27, v135
    v_lshlrev_b32 v136, 16, v34
    v_and_b32 v137, v26, v34
    v_lshlrev_b32 v138, 16, v35
    v_and_b32 v139, v26, v35
    v_exp_f32 v132, v132
    v_exp_f32 v133, v133
    v_exp_f32 v134, v134
    v_exp_f32 v135, v135
    v_mul_f32 v136, v27, v136
    v_mul_f32 v137, v27, v137
    v_mul_f32 v138, v27, v138
    v_mul_f32 v139, v27, v139
    v_cvt_pk_bf16_f32 v36, v108, v109
    v_cvt_pk_bf16_f32 v37, v110, v111
    v_cvt_pk_bf16_f32 v38, v112, v113
    v_cvt_pk_bf16_f32 v39, v114, v115
    v_exp_f32 v136, v136
    v_exp_f32 v137, v137
    v_exp_f32 v138, v138
    v_exp_f32 v139, v139
    v_cvt_pk_bf16_f32 v32, v132, v133
    v_cvt_pk_bf16_f32 v33, v134, v135
    v_lshlrev_b32 v140, 16, v36
    v_and_b32 v141, v26, v36
    v_lshlrev_b32 v142, 16, v37
    v_and_b32 v143, v26, v37
    v_lshlrev_b32 v144, 16, v38
    v_and_b32 v145, v26, v38
    v_lshlrev_b32 v146, 16, v39
    v_and_b32 v147, v26, v39
    v_cvt_pk_bf16_f32 v34, v136, v137
    v_cvt_pk_bf16_f32 v35, v138, v139
    v_mfma_f32_16x16x32_bf16 v[80:83], v[28:31], v[156:159], 0
    v_mul_f32 v140, v27, v140
    v_mul_f32 v141, v27, v141
    v_mul_f32 v142, v27, v142
    v_mul_f32 v143, v27, v143
    v_mul_f32 v144, v27, v144
    v_mul_f32 v145, v27, v145
    v_mul_f32 v146, v27, v146
    v_mul_f32 v147, v27, v147
    v_exp_f32 v140, v140
    v_exp_f32 v141, v141
    v_exp_f32 v142, v142
    v_exp_f32 v143, v143
    v_exp_f32 v144, v144
    v_exp_f32 v145, v145
    v_exp_f32 v146, v146
    v_exp_f32 v147, v147
    v_mfma_f32_16x16x16_bf16 v[100:103], v[180:181], v[32:33], v[184:187]
    v_cvt_pk_bf16_f32 v84, v72, v73
    v_cvt_pk_bf16_f32 v85, v74, v75
    v_cvt_pk_bf16_f32 v86, v76, v77
    v_cvt_pk_bf16_f32 v87, v78, v79
    v_cvt_pk_bf16_f32 v36, v140, v141
    v_cvt_pk_bf16_f32 v37, v142, v143
    v_cvt_pk_bf16_f32 v38, v144, v145
    v_cvt_pk_bf16_f32 v39, v146, v147
    v_mfma_f32_16x16x16_bf16 v[104:107], v[180:181], v[34:35], v[184:187]
    v_cvt_pk_bf16_f32 v88, v80, v81
    v_cvt_pk_bf16_f32 v89, v82, v83
    v_cvt_pk_bf16_f32 v32, v100, v101
    v_mfma_f32_16x16x32_bf16 v[72:75], v[28:31], v[160:163], 0
    v_cvt_pk_bf16_f32 v33, v102, v103
    v_mov_b32 v100, 0x3f803f80
    v_mov_b32 v101, 0x3f803f80
    v_mfma_f32_16x16x32_bf16 v[76:79], v[28:31], v[164:167], 0
    v_cvt_pk_bf16_f32 v34, v104, v105
    v_cvt_pk_bf16_f32 v35, v106, v107
    v_mov_b32 v102, 0x3f803f80
    v_mfma_f32_16x16x16_bf16 v[108:111], v[180:181], v[36:37], v[184:187]
    v_mov_b32 v103, 0x3f803f80
    v_cvt_pk_bf16_f32 v90, v72, v73
    v_cvt_pk_bf16_f32 v91, v74, v75
    v_mfma_f32_16x16x16_bf16 v[112:115], v[180:181], v[38:39], v[184:187]
    v_cvt_pk_bf16_f32 v92, v76, v77
    v_cvt_pk_bf16_f32 v93, v78, v79
    v_mfma_f32_16x16x32_bf16 v[80:83], v[28:31], v[168:171], 0
    s_nop 0
    v_cvt_pk_bf16_f32 v36, v108, v109
    v_cvt_pk_bf16_f32 v37, v110, v111
    v_mfma_f32_16x16x32_bf16 v[72:75], v[28:31], v[172:175], 0
    s_nop 0
    v_cvt_pk_bf16_f32 v38, v112, v113
    v_cvt_pk_bf16_f32 v39, v114, v115
    v_mfma_f32_16x16x32_bf16 v[76:79], v[28:31], v[176:179], 0
    v_cvt_pk_bf16_f32 v94, v80, v81
    v_cvt_pk_bf16_f32 v95, v82, v83
    v_mfma_f32_16x16x32_bf16 v[16:19], v[32:35], v[100:103], 0
    v_subrev_u32 v32, 0x01800180, v32
    v_cvt_pk_bf16_f32 v96, v72, v73
    v_cvt_pk_bf16_f32 v97, v74, v75
    v_mfma_f32_16x16x32_bf16 v[16:19], v[36:39], v[100:103], v[16:19]
    v_subrev_u32 v33, 0x01800180, v33
    v_cvt_pk_bf16_f32 v98, v76, v77
    v_cvt_pk_bf16_f32 v99, v78, v79
    v_mfma_f32_16x16x32_bf16 v[64:67], v[84:87], v[84:87], 0
    v_subrev_u32 v34, 0x01800180, v34
    v_subrev_u32 v35, 0x01800180, v35
    v_subrev_u32 v36, 0x01800180, v36
    v_mfma_f32_16x16x32_bf16 v[116:119], v[192:195], v[84:87], 0
    v_subrev_u32 v37, 0x01800180, v37
    v_subrev_u32 v38, 0x01800180, v38
    v_subrev_u32 v39, 0x01800180, v39
    v_mfma_f32_16x16x32_bf16 v[120:123], v[208:211], v[84:87], 0
    v_mul_f32 v16, v54, v16
    v_mul_f32 v17, v54, v17
    v_mul_f32 v18, v54, v18
    v_mfma_f32_16x16x32_bf16 v[124:127], v[224:227], v[84:87], 0
    v_mul_f32 v19, v54, v19
    v_mfma_f32_16x16x32_bf16 v[128:131], v[240:243], v[84:87], 0
    v_mfma_f32_16x16x32_bf16 v[64:67], v[88:91], v[88:91], v[64:67]
    v_mfma_f32_16x16x32_bf16 v[116:119], v[196:199], v[88:91], v[116:119]
    v_mfma_f32_16x16x32_bf16 v[120:123], v[212:215], v[88:91], v[120:123]
    v_mfma_f32_16x16x32_bf16 v[124:127], v[228:231], v[88:91], v[124:127]
    v_mfma_f32_16x16x32_bf16 v[128:131], v[244:247], v[88:91], v[128:131]
    v_mfma_f32_16x16x32_bf16 v[64:67], v[92:95], v[92:95], v[64:67]
    v_mfma_f32_16x16x32_bf16 v[116:119], v[200:203], v[92:95], v[116:119]
    v_mfma_f32_16x16x32_bf16 v[120:123], v[216:219], v[92:95], v[120:123]
    v_mfma_f32_16x16x32_bf16 v[124:127], v[232:235], v[92:95], v[124:127]
    v_mfma_f32_16x16x32_bf16 v[128:131], v[248:251], v[92:95], v[128:131]
    v_mfma_f32_16x16x32_bf16 v[64:67], v[96:99], v[96:99], v[64:67]
    v_mfma_f32_16x16x32_bf16 v[116:119], v[204:207], v[96:99], v[116:119]
    v_mfma_f32_16x16x32_bf16 v[120:123], v[220:223], v[96:99], v[120:123]
    v_mfma_f32_16x16x32_bf16 v[124:127], v[236:239], v[96:99], v[124:127]
    v_mfma_f32_16x16x32_bf16 v[128:131], v[252:255], v[96:99], v[128:131]
    s_cmp_eq_u32 s60, 0
    s_nop 6
    s_cbranch_scc1 L_noflag
    s_waitcnt vmcnt(0)
    s_mov_b64 exec, 1
    v_mov_b32 v183, 1
    s_lshl_b32 s52, s48, 2
    buffer_atomic_add v183, off, s[40:43], s52 sc1
    s_mov_b64 exec, -1
    s_nop 0
L_noflag:
L_kpoll1:
    ds_read_b32 v183, v12
    s_waitcnt lgkmcnt(0)
    v_readfirstlane_b32 s52, v183
    s_nop 3
    s_cmp_gt_u32 s52, 2
    s_nop 0
    s_cbranch_scc1 L_kready1
    s_sleep 1
    s_add_u32 s58, s58, 1
    s_cmp_lt_u32 s58, 524288
    s_nop 0
    s_cbranch_scc1 L_kpoll1
L_kready1:
    ds_read2st64_b64 v[148:151], v4 offset0:8 offset1:8
    ds_read2st64_b64 v[152:155], v8 offset0:8 offset1:8
    ds_read2st64_b64 v[156:159], v5 offset0:8 offset1:8
    ds_read2st64_b64 v[160:163], v9 offset0:8 offset1:8
    ds_read2st64_b64 v[164:167], v6 offset0:8 offset1:8
    ds_read2st64_b64 v[168:171], v10 offset0:8 offset1:8
    ds_read2st64_b64 v[172:175], v7 offset0:8 offset1:8
    ds_read2st64_b64 v[176:179], v11 offset0:8 offset1:8
    s_waitcnt lgkmcnt(0)
    v_mfma_f32_16x16x32_bf16 v[72:75], v[28:31], v[148:151], 0
    v_cvt_pk_bf16_f32 v52, v64, v65
    v_cvt_pk_bf16_f32 v53, v66, v67
    v_and_b32 v52, v52, v20
    v_mfma_f32_16x16x32_bf16 v[76:79], v[28:31], v[152:155], 0
    v_and_b32 v53, v53, v21
    v_cvt_pk_bf16_f32 v40, v116, v117
    v_cvt_pk_bf16_f32 v41, v118, v119
    v_mfma_f32_16x16x16_bf16 v[48:51], v[22:23], v[52:53], 0
    v_cvt_pk_bf16_f32 v42, v120, v121
    v_cvt_pk_bf16_f32 v43, v122, v123
    v_cvt_pk_bf16_f32 v44, v124, v125
    v_cvt_pk_bf16_f32 v45, v126, v127
    v_cvt_pk_bf16_f32 v46, v128, v129
    v_cvt_pk_bf16_f32 v47, v130, v131
    v_mfma_f32_16x16x16_bf16 v[100:103], v[24:25], v[40:41], v[48:51]
    v_cvt_pk_bf16_f32 v84, v72, v73
    v_cvt_pk_bf16_f32 v85, v74, v75
    v_cvt_pk_bf16_f32 v86, v76, v77
    v_mfma_f32_16x16x16_bf16 v[104:107], v[24:25], v[42:43], v[48:51]
    v_cvt_pk_bf16_f32 v87, v78, v79
    v_mfma_f32_16x16x32_bf16 v[80:83], v[28:31], v[156:159], 0
    s_nop 1
    v_cvt_pk_bf16_f32 v40, v100, v101
    v_mfma_f32_16x16x16_bf16 v[108:111], v[24:25], v[44:45], v[48:51]
    v_cvt_pk_bf16_f32 v41, v102, v103
    v_lshlrev_b32 v116, 16, v40
    v_cvt_pk_bf16_f32 v42, v104, v105
    v_mfma_f32_16x16x16_bf16 v[112:115], v[24:25], v[46:47], v[48:51]
    v_cvt_pk_bf16_f32 v43, v106, v107
    v_and_b32 v117, v26, v40
    v_lshlrev_b32 v118, 16, v41
    v_mfma_f32_16x16x32_bf16 v[72:75], v[28:31], v[160:163], 0
    v_and_b32 v119, v26, v41
    v_lshlrev_b32 v120, 16, v42
    v_and_b32 v121, v26, v42
    v_mfma_f32_16x16x32_bf16 v[76:79], v[28:31], v[164:167], 0
    v_lshlrev_b32 v122, 16, v43
    v_and_b32 v123, v26, v43
    v_cvt_pk_bf16_f32 v88, v80, v81
    v_cvt_pk_bf16_f32 v89, v82, v83
    v_mul_f32 v116, v27, v116
    v_mul_f32 v117, v27, v117
    v_mul_f32 v118, v27, v118
    v_mul_f32 v119, v27, v119
    v_mul_f32 v120, v27, v120
    v_mul_f32 v121, v27, v121
    v_mul_f32 v122, v27, v122
    v_mul_f32 v123, v27, v123
    v_mfma_f32_16x16x32_bf16 v[80:83], v[28:31], v[168:171], 0
    v_cvt_pk_bf16_f32 v44, v108, v109
    v_cvt_pk_bf16_f32 v45, v110, v111
    v_cvt_pk_bf16_f32 v46, v112, v113
    v_cvt_pk_bf16_f32 v47, v114, v115
    v_exp_f32 v116, v116
    v_exp_f32 v117, v117
    v_exp_f32 v118, v118
    v_exp_f32 v119, v119
    v_exp_f32 v120, v120
    v_exp_f32 v121, v121
    v_exp_f32 v122, v122
    v_exp_f32 v123, v123
    v_lshlrev_b32 v124, 16, v44
    v_and_b32 v125, v26, v44
    v_lshlrev_b32 v126, 16, v45
    v_and_b32 v127, v26, v45
    v_lshlrev_b32 v128, 16, v46
    v_and_b32 v129, v26, v46
    v_lshlrev_b32 v130, 16, v47
    v_and_b32 v131, v26, v47
    v_cvt_pk_bf16_f32 v40, v116, v117
    v_cvt_pk_bf16_f32 v41, v118, v119
    v_cvt_pk_bf16_f32 v42, v120, v121
    v_cvt_pk_bf16_f32 v43, v122, v123
    v_cvt_pk_bf16_f32 v90, v72, v73
    v_cvt_pk_bf16_f32 v91, v74, v75
    v_cvt_pk_bf16_f32 v92, v76, v77
    v_cvt_pk_bf16_f32 v93, v78, v79
    v_mul_f32 v124, v27, v124
    v_mul_f32 v125, v27, v125
    v_mul_f32 v126, v27, v126
    v_mul_f32 v127, v27, v127
    v_mul_f32 v128, v27, v128
    v_mul_f32 v129, v27, v129
    v_mul_f32 v130, v27, v130
    v_mul_f32 v131, v27, v131
    v_mfma_f32_16x16x32_bf16 v[72:75], v[28:31], v[172:175], 0
    v_exp_f32 v124, v124
    v_exp_f32 v125, v125
    v_exp_f32 v126, v126
    v_mfma_f32_16x16x32_bf16 v[76:79], v[28:31], v[176:179], 0
    v_exp_f32 v127, v127
    v_exp_f32 v128, v128
    v_exp_f32 v129, v129
    v_exp_f32 v130, v130
    v_exp_f32 v131, v131
    v_cvt_pk_bf16_f32 v44, v124, v125
    v_cvt_pk_bf16_f32 v45, v126, v127
    v_cvt_pk_bf16_f32 v46, v128, v129
    v_cvt_pk_bf16_f32 v47, v130, v131
    v_mfma_f32_16x16x32_bf16 v[56:59], v[32:35], v[40:43], v[16:19]
    v_cvt_pk_bf16_f32 v94, v80, v81
    v_cvt_pk_bf16_f32 v95, v82, v83
    v_cvt_pk_bf16_f32 v96, v72, v73
    v_mfma_f32_16x16x32_bf16 v[56:59], v[36:39], v[44:47], v[56:59]
    v_cvt_pk_bf16_f32 v97, v74, v75
    v_cvt_pk_bf16_f32 v98, v76, v77
    v_cvt_pk_bf16_f32 v99, v78, v79
    v_mfma_f32_16x16x32_bf16 v[68:71], v[84:87], v[84:87], 0
    v_mfma_f32_16x16x32_bf16 v[132:135], v[192:195], v[84:87], 0
    v_mfma_f32_16x16x32_bf16 v[136:139], v[208:211], v[84:87], 0
    s_nop 1
    v_mov_b32_dpp v14, v56 quad_perm:[0,1,2,3] row_mask:0x1 bank_mask:0xf
    v_mfma_f32_16x16x32_bf16 v[140:143], v[224:227], v[84:87], 0
    v_mfma_f32_16x16x32_bf16 v[144:147], v[240:243], v[84:87], 0
    v_mfma_f32_16x16x32_bf16 v[68:71], v[88:91], v[88:91], v[68:71]
    v_mfma_f32_16x16x32_bf16 v[132:135], v[196:199], v[88:91], v[132:135]
    v_mfma_f32_16x16x32_bf16 v[136:139], v[212:215], v[88:91], v[136:139]
    v_mfma_f32_16x16x32_bf16 v[140:143], v[228:231], v[88:91], v[140:143]
    v_mfma_f32_16x16x32_bf16 v[144:147], v[244:247], v[88:91], v[144:147]
    v_mfma_f32_16x16x32_bf16 v[68:71], v[92:95], v[92:95], v[68:71]
    v_mfma_f32_16x16x32_bf16 v[132:135], v[200:203], v[92:95], v[132:135]
    v_mfma_f32_16x16x32_bf16 v[136:139], v[216:219], v[92:95], v[136:139]
    v_mfma_f32_16x16x32_bf16 v[140:143], v[232:235], v[92:95], v[140:143]
    v_mfma_f32_16x16x32_bf16 v[144:147], v[248:251], v[92:95], v[144:147]
    v_mfma_f32_16x16x32_bf16 v[68:71], v[96:99], v[96:99], v[68:71]
    v_mfma_f32_16x16x32_bf16 v[132:135], v[204:207], v[96:99], v[132:135]
    v_mfma_f32_16x16x32_bf16 v[136:139], v[220:223], v[96:99], v[136:139]
    v_mfma_f32_16x16x32_bf16 v[140:143], v[236:239], v[96:99], v[140:143]
    v_mfma_f32_16x16x32_bf16 v[144:147], v[252:255], v[96:99], v[144:147]
    s_nop 7
L_kpoll2:
    ds_read_b32 v183, v12
    s_waitcnt lgkmcnt(0)
    v_readfirstlane_b32 s52, v183
    s_nop 3
    s_cmp_gt_u32 s52, 3
    s_nop 0
    s_cbranch_scc1 L_kready2
    s_sleep 1
    s_add_u32 s58, s58, 1
    s_cmp_lt_u32 s58, 524288
    s_nop 0
    s_cbranch_scc1 L_kpoll2
L_kready2:
    ds_read2st64_b64 v[148:151], v4 offset0:16 offset1:16
    ds_read2st64_b64 v[152:155], v8 offset0:16 offset1:16
    ds_read2st64_b64 v[156:159], v5 offset0:16 offset1:16
    ds_read2st64_b64 v[160:163], v9 offset0:16 offset1:16
    ds_read2st64_b64 v[164:167], v6 offset0:16 offset1:16
    ds_read2st64_b64 v[168:171], v10 offset0:16 offset1:16
    ds_read2st64_b64 v[172:175], v7 offset0:16 offset1:16
    ds_read2st64_b64 v[176:179], v11 offset0:16 offset1:16
    s_waitcnt lgkmcnt(0)
    v_mfma_f32_16x16x32_bf16 v[72:75], v[28:31], v[148:151], 0
    v_cvt_pk_bf16_f32 v52, v68, v69
    v_cvt_pk_bf16_f32 v53, v70, v71
    v_and_b32 v52, v52, v20
    v_mfma_f32_16x16x32_bf16 v[76:79], v[28:31], v[152:155], 0
    v_and_b32 v53, v53, v21
    v_cvt_pk_bf16_f32 v40, v132, v133
    v_cvt_pk_bf16_f32 v41, v134, v135
    v_mfma_f32_16x16x16_bf16 v[48:51], v[22:23], v[52:53], 0
    v_cvt_pk_bf16_f32 v42, v136, v137
    v_cvt_pk_bf16_f32 v43, v138, v139
    v_cvt_pk_bf16_f32 v44, v140, v141
    v_cvt_pk_bf16_f32 v45, v142, v143
    v_cvt_pk_bf16_f32 v46, v144, v145
    v_cvt_pk_bf16_f32 v47, v146, v147
    v_mfma_f32_16x16x16_bf16 v[100:103], v[24:25], v[40:41], v[48:51]
    v_cvt_pk_bf16_f32 v84, v72, v73
    v_cvt_pk_bf16_f32 v85, v74, v75
    v_cvt_pk_bf16_f32 v86, v76, v77
    v_mfma_f32_16x16x16_bf16 v[104:107], v[24:25], v[42:43], v[48:51]
    v_cvt_pk_bf16_f32 v87, v78, v79
    v_mfma_f32_16x16x32_bf16 v[80:83], v[28:31], v[156:159], 0
    s_nop 1
    v_cvt_pk_bf16_f32 v40, v100, v101
    v_mfma_f32_16x16x16_bf16 v[108:111], v[24:25], v[44:45], v[48:51]
    v_cvt_pk_bf16_f32 v41, v102, v103
    v_lshlrev_b32 v132, 16, v40
    v_cvt_pk_bf16_f32 v42, v104, v105
    v_mfma_f32_16x16x16_bf16 v[112:115], v[24:25], v[46:47], v[48:51]
    v_cvt_pk_bf16_f32 v43, v106, v107
    v_and_b32 v133, v26, v40
    v_lshlrev_b32 v134, 16, v41
    v_mfma_f32_16x16x32_bf16 v[72:75], v[28:31], v[160:163], 0
    v_and_b32 v135, v26, v41
    v_lshlrev_b32 v136, 16, v42
    v_and_b32 v137, v26, v42
    v_mfma_f32_16x16x32_bf16 v[76:79], v[28:31], v[164:167], 0
    v_lshlrev_b32 v138, 16, v43
    v_and_b32 v139, v26, v43
    v_cvt_pk_bf16_f32 v88, v80, v81
    v_cvt_pk_bf16_f32 v89, v82, v83
    v_mul_f32 v132, v27, v132
    v_mul_f32 v133, v27, v133
    v_mul_f32 v134, v27, v134
    v_mul_f32 v135, v27, v135
    v_mul_f32 v136, v27, v136
    v_mul_f32 v137, v27, v137
    v_mul_f32 v138, v27, v138
    v_mul_f32 v139, v27, v139
    v_mfma_f32_16x16x32_bf16 v[80:83], v[28:31], v[168:171], 0
    v_cvt_pk_bf16_f32 v44, v108, v109
    v_cvt_pk_bf16_f32 v45, v110, v111
    v_cvt_pk_bf16_f32 v46, v112, v113
    v_cvt_pk_bf16_f32 v47, v114, v115
    v_exp_f32 v132, v132
    v_exp_f32 v133, v133
    v_exp_f32 v134, v134
    v_exp_f32 v135, v135
    v_exp_f32 v136, v136
    v_exp_f32 v137, v137
    v_exp_f32 v138, v138
    v_exp_f32 v139, v139
    v_lshlrev_b32 v140, 16, v44
    v_and_b32 v141, v26, v44
    v_lshlrev_b32 v142, 16, v45
    v_and_b32 v143, v26, v45
    v_lshlrev_b32 v144, 16, v46
    v_and_b32 v145, v26, v46
    v_lshlrev_b32 v146, 16, v47
    v_and_b32 v147, v26, v47
    v_cvt_pk_bf16_f32 v40, v132, v133
    v_cvt_pk_bf16_f32 v41, v134, v135
    v_cvt_pk_bf16_f32 v42, v136, v137
    v_cvt_pk_bf16_f32 v43, v138, v139
    v_cvt_pk_bf16_f32 v90, v72, v73
    v_cvt_pk_bf16_f32 v91, v74, v75
    v_cvt_pk_bf16_f32 v92, v76, v77
    v_cvt_pk_bf16_f32 v93, v78, v79
    v_mul_f32 v140, v27, v140
    v_mul_f32 v141, v27, v141
    v_mul_f32 v142, v27, v142
    v_mul_f32 v143, v27, v143
    v_mul_f32 v144, v27, v144
    v_mul_f32 v145, v27, v145
    v_mul_f32 v146, v27, v146
    v_mul_f32 v147, v27, v147
    v_mfma_f32_16x16x32_bf16 v[72:75], v[28:31], v[172:175], 0
    v_exp_f32 v140, v140
    v_exp_f32 v141, v141
    v_exp_f32 v142, v142
    v_mfma_f32_16x16x32_bf16 v[76:79], v[28:31], v[176:179], 0
    v_exp_f32 v143, v143
    v_exp_f32 v144, v144
    v_exp_f32 v145, v145
    v_exp_f32 v146, v146
    v_exp_f32 v147, v147
    v_cvt_pk_bf16_f32 v44, v140, v141
    v_cvt_pk_bf16_f32 v45, v142, v143
    v_cvt_pk_bf16_f32 v46, v144, v145
    v_cvt_pk_bf16_f32 v47, v146, v147
    v_mfma_f32_16x16x32_bf16 v[60:63], v[32:35], v[40:43], v[16:19]
    v_cvt_pk_bf16_f32 v94, v80, v81
    v_cvt_pk_bf16_f32 v95, v82, v83
    v_cvt_pk_bf16_f32 v96, v72, v73
    v_mfma_f32_16x16x32_bf16 v[60:63], v[36:39], v[44:47], v[60:63]
    v_cvt_pk_bf16_f32 v97, v74, v75
    v_cvt_pk_bf16_f32 v98, v76, v77
    v_cvt_pk_bf16_f32 v99, v78, v79
    v_mfma_f32_16x16x32_bf16 v[64:67], v[84:87], v[84:87], 0
    v_mfma_f32_16x16x32_bf16 v[116:119], v[192:195], v[84:87], 0
    v_mfma_f32_16x16x32_bf16 v[120:123], v[208:211], v[84:87], 0
    s_nop 1
    v_mov_b32_dpp v14, v60 quad_perm:[0,1,2,3] row_mask:0x2 bank_mask:0xf
    v_mfma_f32_16x16x32_bf16 v[124:127], v[224:227], v[84:87], 0
    v_mfma_f32_16x16x32_bf16 v[128:131], v[240:243], v[84:87], 0
    v_mfma_f32_16x16x32_bf16 v[64:67], v[88:91], v[88:91], v[64:67]
    v_mfma_f32_16x16x32_bf16 v[116:119], v[196:199], v[88:91], v[116:119]
    v_mfma_f32_16x16x32_bf16 v[120:123], v[212:215], v[88:91], v[120:123]
    v_mfma_f32_16x16x32_bf16 v[124:127], v[228:231], v[88:91], v[124:127]
    v_mfma_f32_16x16x32_bf16 v[128:131], v[244:247], v[88:91], v[128:131]
    v_mfma_f32_16x16x32_bf16 v[64:67], v[92:95], v[92:95], v[64:67]
    v_mfma_f32_16x16x32_bf16 v[116:119], v[200:203], v[92:95], v[116:119]
    v_mfma_f32_16x16x32_bf16 v[120:123], v[216:219], v[92:95], v[120:123]
    v_mfma_f32_16x16x32_bf16 v[124:127], v[232:235], v[92:95], v[124:127]
    v_mfma_f32_16x16x32_bf16 v[128:131], v[248:251], v[92:95], v[128:131]
    v_mfma_f32_16x16x32_bf16 v[64:67], v[96:99], v[96:99], v[64:67]
    v_mfma_f32_16x16x32_bf16 v[116:119], v[204:207], v[96:99], v[116:119]
    v_mfma_f32_16x16x32_bf16 v[120:123], v[220:223], v[96:99], v[120:123]
    v_mfma_f32_16x16x32_bf16 v[124:127], v[236:239], v[96:99], v[124:127]
    v_mfma_f32_16x16x32_bf16 v[128:131], v[252:255], v[96:99], v[128:131]
    s_nop 7
L_kpoll3:
    ds_read_b32 v183, v12
    s_waitcnt lgkmcnt(0)
    v_readfirstlane_b32 s52, v183
    s_nop 3
    s_cmp_gt_u32 s52, 4
    s_nop 0
    s_cbranch_scc1 L_kready3
    s_sleep 1
    s_add_u32 s58, s58, 1
    s_cmp_lt_u32 s58, 524288
    s_nop 0
    s_cbranch_scc1 L_kpoll3
L_kready3:
    ds_read2st64_b64 v[148:151], v4 offset0:24 offset1:24
    ds_read2st64_b64 v[152:155], v8 offset0:24 offset1:24
    ds_read2st64_b64 v[156:159], v5 offset0:24 offset1:24
    ds_read2st64_b64 v[160:163], v9 offset0:24 offset1:24
    ds_read2st64_b64 v[164:167], v6 offset0:24 offset1:24
    ds_read2st64_b64 v[168:171], v10 offset0:24 offset1:24
    ds_read2st64_b64 v[172:175], v7 offset0:24 offset1:24
    ds_read2st64_b64 v[176:179], v11 offset0:24 offset1:24
    s_waitcnt lgkmcnt(0)
    v_mfma_f32_16x16x32_bf16 v[72:75], v[28:31], v[148:151], 0
    v_cvt_pk_bf16_f32 v52, v64, v65
    v_cvt_pk_bf16_f32 v53, v66, v67
    v_and_b32 v52, v52, v20
    v_mfma_f32_16x16x32_bf16 v[76:79], v[28:31], v[152:155], 0
    v_and_b32 v53, v53, v21
    v_cvt_pk_bf16_f32 v40, v116, v117
    v_cvt_pk_bf16_f32 v41, v118, v119
    v_mfma_f32_16x16x16_bf16 v[48:51], v[22:23], v[52:53], 0
    v_cvt_pk_bf16_f32 v42, v120, v121
    v_cvt_pk_bf16_f32 v43, v122, v123
    v_cvt_pk_bf16_f32 v44, v124, v125
    v_cvt_pk_bf16_f32 v45, v126, v127
    v_cvt_pk_bf16_f32 v46, v128, v129
    v_cvt_pk_bf16_f32 v47, v130, v131
    v_mfma_f32_16x16x16_bf16 v[100:103], v[24:25], v[40:41], v[48:51]
    v_cvt_pk_bf16_f32 v84, v72, v73
    v_cvt_pk_bf16_f32 v85, v74, v75
    v_cvt_pk_bf16_f32 v86, v76, v77
    v_mfma_f32_16x16x16_bf16 v[104:107], v[24:25], v[42:43], v[48:51]
    v_cvt_pk_bf16_f32 v87, v78, v79
    v_mfma_f32_16x16x32_bf16 v[80:83], v[28:31], v[156:159], 0
    s_nop 1
    v_cvt_pk_bf16_f32 v40, v100, v101
    v_mfma_f32_16x16x16_bf16 v[108:111], v[24:25], v[44:45], v[48:51]
    v_cvt_pk_bf16_f32 v41, v102, v103
    v_lshlrev_b32 v116, 16, v40
    v_cvt_pk_bf16_f32 v42, v104, v105
    v_mfma_f32_16x16x16_bf16 v[112:115], v[24:25], v[46:47], v[48:51]
    v_cvt_pk_bf16_f32 v43, v106, v107
    v_and_b32 v117, v26, v40
    v_lshlrev_b32 v118, 16, v41
    v_mfma_f32_16x16x32_bf16 v[72:75], v[28:31], v[160:163], 0
    v_and_b32 v119, v26, v41
    v_lshlrev_b32 v120, 16, v42
    v_and_b32 v121, v26, v42
    v_mfma_f32_16x16x32_bf16 v[76:79], v[28:31], v[164:167], 0
    v_lshlrev_b32 v122, 16, v43
    v_and_b32 v123, v26, v43
    v_cvt_pk_bf16_f32 v88, v80, v81
    v_cvt_pk_bf16_f32 v89, v82, v83
    v_mul_f32 v116, v27, v116
    v_mul_f32 v117, v27, v117
    v_mul_f32 v118, v27, v118
    v_mul_f32 v119, v27, v119
    v_mul_f32 v120, v27, v120
    v_mul_f32 v121, v27, v121
    v_mul_f32 v122, v27, v122
    v_mul_f32 v123, v27, v123
    v_mfma_f32_16x16x32_bf16 v[80:83], v[28:31], v[168:171], 0
    v_cvt_pk_bf16_f32 v44, v108, v109
    v_cvt_pk_bf16_f32 v45, v110, v111
    v_cvt_pk_bf16_f32 v46, v112, v113
    v_cvt_pk_bf16_f32 v47, v114, v115
    v_exp_f32 v116, v116
    v_exp_f32 v117, v117
    v_exp_f32 v118, v118
    v_exp_f32 v119, v119
    v_exp_f32 v120, v120
    v_exp_f32 v121, v121
    v_exp_f32 v122, v122
    v_exp_f32 v123, v123
    v_lshlrev_b32 v124, 16, v44
    v_and_b32 v125, v26, v44
    v_lshlrev_b32 v126, 16, v45
    v_and_b32 v127, v26, v45
    v_lshlrev_b32 v128, 16, v46
    v_and_b32 v129, v26, v46
    v_lshlrev_b32 v130, 16, v47
    v_and_b32 v131, v26, v47
    v_cvt_pk_bf16_f32 v40, v116, v117
    v_cvt_pk_bf16_f32 v41, v118, v119
    v_cvt_pk_bf16_f32 v42, v120, v121
    v_cvt_pk_bf16_f32 v43, v122, v123
    v_cvt_pk_bf16_f32 v90, v72, v73
    v_cvt_pk_bf16_f32 v91, v74, v75
    v_cvt_pk_bf16_f32 v92, v76, v77
    v_cvt_pk_bf16_f32 v93, v78, v79
    v_mul_f32 v124, v27, v124
    v_mul_f32 v125, v27, v125
    v_mul_f32 v126, v27, v126
    v_mul_f32 v127, v27, v127
    v_mul_f32 v128, v27, v128
    v_mul_f32 v129, v27, v129
    v_mul_f32 v130, v27, v130
    v_mul_f32 v131, v27, v131
    v_mfma_f32_16x16x32_bf16 v[72:75], v[28:31], v[172:175], 0
    v_exp_f32 v124, v124
    v_exp_f32 v125, v125
    v_exp_f32 v126, v126
    v_mfma_f32_16x16x32_bf16 v[76:79], v[28:31], v[176:179], 0
    v_exp_f32 v127, v127
    v_exp_f32 v128, v128
    v_exp_f32 v129, v129
    v_exp_f32 v130, v130
    v_exp_f32 v131, v131
    v_cvt_pk_bf16_f32 v44, v124, v125
    v_cvt_pk_bf16_f32 v45, v126, v127
    v_cvt_pk_bf16_f32 v46, v128, v129
    v_cvt_pk_bf16_f32 v47, v130, v131
    v_mfma_f32_16x16x32_bf16 v[56:59], v[32:35], v[40:43], v[16:19]
    v_cvt_pk_bf16_f32 v94, v80, v81
    v_cvt_pk_bf16_f32 v95, v82, v83
    v_cvt_pk_bf16_f32 v96, v72, v73
    v_mfma_f32_16x16x32_bf16 v[56:59], v[36:39], v[44:47], v[56:59]
    v_cvt_pk_bf16_f32 v97, v74, v75
    v_cvt_pk_bf16_f32 v98, v76, v77
    v_cvt_pk_bf16_f32 v99, v78, v79
    v_mfma_f32_16x16x32_bf16 v[68:71], v[84:87], v[84:87], 0
    v_mfma_f32_16x16x32_bf16 v[132:135], v[192:195], v[84:87], 0
    v_mfma_f32_16x16x32_bf16 v[136:139], v[208:211], v[84:87], 0
    s_nop 1
    v_mov_b32_dpp v14, v56 quad_perm:[0,1,2,3] row_mask:0x4 bank_mask:0xf
    v_mfma_f32_16x16x32_bf16 v[140:143], v[224:227], v[84:87], 0
    v_mfma_f32_16x16x32_bf16 v[144:147], v[240:243], v[84:87], 0
    v_mfma_f32_16x16x32_bf16 v[68:71], v[88:91], v[88:91], v[68:71]
    v_mfma_f32_16x16x32_bf16 v[132:135], v[196:199], v[88:91], v[132:135]
    v_mfma_f32_16x16x32_bf16 v[136:139], v[212:215], v[88:91], v[136:139]
    v_mfma_f32_16x16x32_bf16 v[140:143], v[228:231], v[88:91], v[140:143]
    v_mfma_f32_16x16x32_bf16 v[144:147], v[244:247], v[88:91], v[144:147]
    v_mfma_f32_16x16x32_bf16 v[68:71], v[92:95], v[92:95], v[68:71]
    v_mfma_f32_16x16x32_bf16 v[132:135], v[200:203], v[92:95], v[132:135]
    v_mfma_f32_16x16x32_bf16 v[136:139], v[216:219], v[92:95], v[136:139]
    v_mfma_f32_16x16x32_bf16 v[140:143], v[232:235], v[92:95], v[140:143]
    v_mfma_f32_16x16x32_bf16 v[144:147], v[248:251], v[92:95], v[144:147]
    v_mfma_f32_16x16x32_bf16 v[68:71], v[96:99], v[96:99], v[68:71]
    v_mfma_f32_16x16x32_bf16 v[132:135], v[204:207], v[96:99], v[132:135]
    v_mfma_f32_16x16x32_bf16 v[136:139], v[220:223], v[96:99], v[136:139]
    v_mfma_f32_16x16x32_bf16 v[140:143], v[236:239], v[96:99], v[140:143]
    v_mfma_f32_16x16x32_bf16 v[144:147], v[252:255], v[96:99], v[144:147]
    s_nop 7
L_kpoll4:
    ds_read_b32 v183, v12
    s_waitcnt lgkmcnt(0)
    v_readfirstlane_b32 s52, v183
    s_nop 3
    s_cmp_gt_u32 s52, 5
    s_nop 0
    s_cbranch_scc1 L_kready4
    s_sleep 1
    s_add_u32 s58, s58, 1
    s_cmp_lt_u32 s58, 524288
    s_nop 0
    s_cbranch_scc1 L_kpoll4
L_kready4:
    ds_read2st64_b64 v[148:151], v4 offset0:32 offset1:32
    ds_read2st64_b64 v[152:155], v8 offset0:32 offset1:32
    ds_read2st64_b64 v[156:159], v5 offset0:32 offset1:32
    ds_read2st64_b64 v[160:163], v9 offset0:32 offset1:32
    ds_read2st64_b64 v[164:167], v6 offset0:32 offset1:32
    ds_read2st64_b64 v[168:171], v10 offset0:32 offset1:32
    ds_read2st64_b64 v[172:175], v7 offset0:32 offset1:32
    ds_read2st64_b64 v[176:179], v11 offset0:32 offset1:32
    s_waitcnt lgkmcnt(0)
    v_mfma_f32_16x16x32_bf16 v[72:75], v[28:31], v[148:151], 0
    v_cvt_pk_bf16_f32 v52, v68, v69
    v_cvt_pk_bf16_f32 v53, v70, v71
    v_and_b32 v52, v52, v20
    v_mfma_f32_16x16x32_bf16 v[76:79], v[28:31], v[152:155], 0
    v_and_b32 v53, v53, v21
    v_cvt_pk_bf16_f32 v40, v132, v133
    v_cvt_pk_bf16_f32 v41, v134, v135
    v_mfma_f32_16x16x16_bf16 v[48:51], v[22:23], v[52:53], 0
    v_cvt_pk_bf16_f32 v42, v136, v137
    v_cvt_pk_bf16_f32 v43, v138, v139
    v_cvt_pk_bf16_f32 v44, v140, v141
    v_cvt_pk_bf16_f32 v45, v142, v143
    v_cvt_pk_bf16_f32 v46, v144, v145
    v_cvt_pk_bf16_f32 v47, v146, v147
    v_mfma_f32_16x16x16_bf16 v[100:103], v[24:25], v[40:41], v[48:51]
    v_cvt_pk_bf16_f32 v84, v72, v73
    v_cvt_pk_bf16_f32 v85, v74, v75
    v_cvt_pk_bf16_f32 v86, v76, v77
    v_mfma_f32_16x16x16_bf16 v[104:107], v[24:25], v[42:43], v[48:51]
    v_cvt_pk_bf16_f32 v87, v78, v79
    v_mfma_f32_16x16x32_bf16 v[80:83], v[28:31], v[156:159], 0
    s_nop 1
    v_cvt_pk_bf16_f32 v40, v100, v101
    v_mfma_f32_16x16x16_bf16 v[108:111], v[24:25], v[44:45], v[48:51]
    v_cvt_pk_bf16_f32 v41, v102, v103
    v_lshlrev_b32 v132, 16, v40
    v_cvt_pk_bf16_f32 v42, v104, v105
    v_mfma_f32_16x16x16_bf16 v[112:115], v[24:25], v[46:47], v[48:51]
    v_cvt_pk_bf16_f32 v43, v106, v107
    v_and_b32 v133, v26, v40
    v_lshlrev_b32 v134, 16, v41
    v_mfma_f32_16x16x32_bf16 v[72:75], v[28:31], v[160:163], 0
    v_and_b32 v135, v26, v41
    v_lshlrev_b32 v136, 16, v42
    v_and_b32 v137, v26, v42
    v_mfma_f32_16x16x32_bf16 v[76:79], v[28:31], v[164:167], 0
    v_lshlrev_b32 v138, 16, v43
    v_and_b32 v139, v26, v43
    v_cvt_pk_bf16_f32 v88, v80, v81
    v_cvt_pk_bf16_f32 v89, v82, v83
    v_mul_f32 v132, v27, v132
    v_mul_f32 v133, v27, v133
    v_mul_f32 v134, v27, v134
    v_mul_f32 v135, v27, v135
    v_mul_f32 v136, v27, v136
    v_mul_f32 v137, v27, v137
    v_mul_f32 v138, v27, v138
    v_mul_f32 v139, v27, v139
    v_mfma_f32_16x16x32_bf16 v[80:83], v[28:31], v[168:171], 0
    v_cvt_pk_bf16_f32 v44, v108, v109
    v_cvt_pk_bf16_f32 v45, v110, v111
    v_cvt_pk_bf16_f32 v46, v112, v113
    v_cvt_pk_bf16_f32 v47, v114, v115
    v_exp_f32 v132, v132
    v_exp_f32 v133, v133
    v_exp_f32 v134, v134
    v_exp_f32 v135, v135
    v_exp_f32 v136, v136
    v_exp_f32 v137, v137
    v_exp_f32 v138, v138
    v_exp_f32 v139, v139
    v_lshlrev_b32 v140, 16, v44
    v_and_b32 v141, v26, v44
    v_lshlrev_b32 v142, 16, v45
    v_and_b32 v143, v26, v45
    v_lshlrev_b32 v144, 16, v46
    v_and_b32 v145, v26, v46
    v_lshlrev_b32 v146, 16, v47
    v_and_b32 v147, v26, v47
    v_cvt_pk_bf16_f32 v40, v132, v133
    v_cvt_pk_bf16_f32 v41, v134, v135
    v_cvt_pk_bf16_f32 v42, v136, v137
    v_cvt_pk_bf16_f32 v43, v138, v139
    v_cvt_pk_bf16_f32 v90, v72, v73
    v_cvt_pk_bf16_f32 v91, v74, v75
    v_cvt_pk_bf16_f32 v92, v76, v77
    v_cvt_pk_bf16_f32 v93, v78, v79
    v_mul_f32 v140, v27, v140
    v_mul_f32 v141, v27, v141
    v_mul_f32 v142, v27, v142
    v_mul_f32 v143, v27, v143
    v_mul_f32 v144, v27, v144
    v_mul_f32 v145, v27, v145
    v_mul_f32 v146, v27, v146
    v_mul_f32 v147, v27, v147
    v_mfma_f32_16x16x32_bf16 v[72:75], v[28:31], v[172:175], 0
    v_exp_f32 v140, v140
    v_exp_f32 v141, v141
    v_exp_f32 v142, v142
    v_mfma_f32_16x16x32_bf16 v[76:79], v[28:31], v[176:179], 0
    v_exp_f32 v143, v143
    v_exp_f32 v144, v144
    v_exp_f32 v145, v145
    v_exp_f32 v146, v146
    v_exp_f32 v147, v147
    v_cvt_pk_bf16_f32 v44, v140, v141
    v_cvt_pk_bf16_f32 v45, v142, v143
    v_cvt_pk_bf16_f32 v46, v144, v145
    v_cvt_pk_bf16_f32 v47, v146, v147
    v_mfma_f32_16x16x32_bf16 v[60:63], v[32:35], v[40:43], v[16:19]
    v_cvt_pk_bf16_f32 v94, v80, v81
    v_cvt_pk_bf16_f32 v95, v82, v83
    v_cvt_pk_bf16_f32 v96, v72, v73
    v_mfma_f32_16x16x32_bf16 v[60:63], v[36:39], v[44:47], v[60:63]
    v_cvt_pk_bf16_f32 v97, v74, v75
    v_cvt_pk_bf16_f32 v98, v76, v77
    v_cvt_pk_bf16_f32 v99, v78, v79
    v_mfma_f32_16x16x32_bf16 v[64:67], v[84:87], v[84:87], 0
    v_mfma_f32_16x16x32_bf16 v[116:119], v[192:195], v[84:87], 0
    v_mfma_f32_16x16x32_bf16 v[120:123], v[208:211], v[84:87], 0
    s_nop 1
    v_mov_b32_dpp v14, v60 quad_perm:[0,1,2,3] row_mask:0x8 bank_mask:0xf
    v_mfma_f32_16x16x32_bf16 v[124:127], v[224:227], v[84:87], 0
    v_mfma_f32_16x16x32_bf16 v[128:131], v[240:243], v[84:87], 0
    v_mfma_f32_16x16x32_bf16 v[64:67], v[88:91], v[88:91], v[64:67]
    v_mfma_f32_16x16x32_bf16 v[116:119], v[196:199], v[88:91], v[116:119]
    v_mfma_f32_16x16x32_bf16 v[120:123], v[212:215], v[88:91], v[120:123]
    v_mfma_f32_16x16x32_bf16 v[124:127], v[228:231], v[88:91], v[124:127]
    v_mfma_f32_16x16x32_bf16 v[128:131], v[244:247], v[88:91], v[128:131]
    v_mfma_f32_16x16x32_bf16 v[64:67], v[92:95], v[92:95], v[64:67]
    v_mfma_f32_16x16x32_bf16 v[116:119], v[200:203], v[92:95], v[116:119]
    v_mfma_f32_16x16x32_bf16 v[120:123], v[216:219], v[92:95], v[120:123]
    v_mfma_f32_16x16x32_bf16 v[124:127], v[232:235], v[92:95], v[124:127]
    v_mfma_f32_16x16x32_bf16 v[128:131], v[248:251], v[92:95], v[128:131]
    v_mfma_f32_16x16x32_bf16 v[64:67], v[96:99], v[96:99], v[64:67]
    v_mfma_f32_16x16x32_bf16 v[116:119], v[204:207], v[96:99], v[116:119]
    v_mfma_f32_16x16x32_bf16 v[120:123], v[220:223], v[96:99], v[120:123]
    v_mfma_f32_16x16x32_bf16 v[124:127], v[236:239], v[96:99], v[124:127]
    v_mfma_f32_16x16x32_bf16 v[128:131], v[252:255], v[96:99], v[128:131]
    s_nop 7
L_kpoll5:
    ds_read_b32 v183, v12
    s_waitcnt lgkmcnt(0)
    v_readfirstlane_b32 s52, v183
    s_nop 3
    s_cmp_gt_u32 s52, 6
    s_nop 0
    s_cbranch_scc1 L_kready5
    s_sleep 1
    s_add_u32 s58, s58, 1
    s_cmp_lt_u32 s58, 524288
    s_nop 0
    s_cbranch_scc1 L_kpoll5
L_kready5:
    ds_read2st64_b64 v[148:151], v4 offset0:40 offset1:40
    ds_read2st64_b64 v[152:155], v8 offset0:40 offset1:40
    ds_read2st64_b64 v[156:159], v5 offset0:40 offset1:40
    ds_read2st64_b64 v[160:163], v9 offset0:40 offset1:40
    ds_read2st64_b64 v[164:167], v6 offset0:40 offset1:40
    ds_read2st64_b64 v[168:171], v10 offset0:40 offset1:40
    ds_read2st64_b64 v[172:175], v7 offset0:40 offset1:40
    ds_read2st64_b64 v[176:179], v11 offset0:40 offset1:40
    s_waitcnt lgkmcnt(0)
    v_mfma_f32_16x16x32_bf16 v[72:75], v[28:31], v[148:151], 0
    v_cvt_pk_bf16_f32 v52, v64, v65
    v_cvt_pk_bf16_f32 v53, v66, v67
    v_and_b32 v52, v52, v20
    v_mfma_f32_16x16x32_bf16 v[76:79], v[28:31], v[152:155], 0
    v_and_b32 v53, v53, v21
    v_cvt_pk_bf16_f32 v40, v116, v117
    v_cvt_pk_bf16_f32 v41, v118, v119
    v_mfma_f32_16x16x16_bf16 v[48:51], v[22:23], v[52:53], 0
    v_cvt_pk_bf16_f32 v42, v120, v121
    v_cvt_pk_bf16_f32 v43, v122, v123
    v_cvt_pk_bf16_f32 v44, v124, v125
    v_cvt_pk_bf16_f32 v45, v126, v127
    v_cvt_pk_bf16_f32 v46, v128, v129
    v_cvt_pk_bf16_f32 v47, v130, v131
    v_mfma_f32_16x16x16_bf16 v[100:103], v[24:25], v[40:41], v[48:51]
    v_cvt_pk_bf16_f32 v84, v72, v73
    v_cvt_pk_bf16_f32 v85, v74, v75
    v_cvt_pk_bf16_f32 v86, v76, v77
    v_mfma_f32_16x16x16_bf16 v[104:107], v[24:25], v[42:43], v[48:51]
    v_cvt_pk_bf16_f32 v87, v78, v79
    v_mfma_f32_16x16x32_bf16 v[80:83], v[28:31], v[156:159], 0
    s_nop 1
    v_cvt_pk_bf16_f32 v40, v100, v101
    v_mfma_f32_16x16x16_bf16 v[108:111], v[24:25], v[44:45], v[48:51]
    v_cvt_pk_bf16_f32 v41, v102, v103
    v_lshlrev_b32 v116, 16, v40
    v_cvt_pk_bf16_f32 v42, v104, v105
    v_mfma_f32_16x16x16_bf16 v[112:115], v[24:25], v[46:47], v[48:51]
    v_cvt_pk_bf16_f32 v43, v106, v107
    v_and_b32 v117, v26, v40
    v_lshlrev_b32 v118, 16, v41
    v_mfma_f32_16x16x32_bf16 v[72:75], v[28:31], v[160:163], 0
    v_and_b32 v119, v26, v41
    v_lshlrev_b32 v120, 16, v42
    v_and_b32 v121, v26, v42
    v_mfma_f32_16x16x32_bf16 v[76:79], v[28:31], v[164:167], 0
    v_lshlrev_b32 v122, 16, v43
    v_and_b32 v123, v26, v43
    v_cvt_pk_bf16_f32 v88, v80, v81
    v_cvt_pk_bf16_f32 v89, v82, v83
    v_mul_f32 v116, v27, v116
    v_mul_f32 v117, v27, v117
    v_mul_f32 v118, v27, v118
    v_mul_f32 v119, v27, v119
    v_mul_f32 v120, v27, v120
    v_mul_f32 v121, v27, v121
    v_mul_f32 v122, v27, v122
    v_mul_f32 v123, v27, v123
    v_mfma_f32_16x16x32_bf16 v[80:83], v[28:31], v[168:171], 0
    v_cvt_pk_bf16_f32 v44, v108, v109
    v_cvt_pk_bf16_f32 v45, v110, v111
    v_cvt_pk_bf16_f32 v46, v112, v113
    v_cvt_pk_bf16_f32 v47, v114, v115
    v_exp_f32 v116, v116
    v_exp_f32 v117, v117
    v_exp_f32 v118, v118
    v_exp_f32 v119, v119
    v_exp_f32 v120, v120
    v_exp_f32 v121, v121
    v_exp_f32 v122, v122
    v_exp_f32 v123, v123
    v_lshlrev_b32 v124, 16, v44
    v_and_b32 v125, v26, v44
    v_lshlrev_b32 v126, 16, v45
    v_and_b32 v127, v26, v45
    v_lshlrev_b32 v128, 16, v46
    v_and_b32 v129, v26, v46
    v_lshlrev_b32 v130, 16, v47
    v_and_b32 v131, v26, v47
    v_cvt_pk_bf16_f32 v40, v116, v117
    v_cvt_pk_bf16_f32 v41, v118, v119
    v_cvt_pk_bf16_f32 v42, v120, v121
    v_cvt_pk_bf16_f32 v43, v122, v123
    v_cvt_pk_bf16_f32 v90, v72, v73
    v_cvt_pk_bf16_f32 v91, v74, v75
    v_cvt_pk_bf16_f32 v92, v76, v77
    v_cvt_pk_bf16_f32 v93, v78, v79
    v_mul_f32 v124, v27, v124
    v_mul_f32 v125, v27, v125
    v_mul_f32 v126, v27, v126
    v_mul_f32 v127, v27, v127
    v_mul_f32 v128, v27, v128
    v_mul_f32 v129, v27, v129
    v_mul_f32 v130, v27, v130
    v_mul_f32 v131, v27, v131
    v_mfma_f32_16x16x32_bf16 v[72:75], v[28:31], v[172:175], 0
    v_exp_f32 v124, v124
    v_exp_f32 v125, v125
    v_exp_f32 v126, v126
    v_mfma_f32_16x16x32_bf16 v[76:79], v[28:31], v[176:179], 0
    v_exp_f32 v127, v127
    v_exp_f32 v128, v128
    v_exp_f32 v129, v129
    v_exp_f32 v130, v130
    v_exp_f32 v131, v131
    v_cvt_pk_bf16_f32 v44, v124, v125
    v_cvt_pk_bf16_f32 v45, v126, v127
    v_cvt_pk_bf16_f32 v46, v128, v129
    v_cvt_pk_bf16_f32 v47, v130, v131
    v_mfma_f32_16x16x32_bf16 v[56:59], v[32:35], v[40:43], v[16:19]
    v_cvt_pk_bf16_f32 v94, v80, v81
    v_cvt_pk_bf16_f32 v95, v82, v83
    v_cvt_pk_bf16_f32 v96, v72, v73
    v_mfma_f32_16x16x32_bf16 v[56:59], v[36:39], v[44:47], v[56:59]
    v_cvt_pk_bf16_f32 v97, v74, v75
    v_cvt_pk_bf16_f32 v98, v76, v77
    v_cvt_pk_bf16_f32 v99, v78, v79
    v_mfma_f32_16x16x32_bf16 v[68:71], v[84:87], v[84:87], 0
    v_mfma_f32_16x16x32_bf16 v[132:135], v[192:195], v[84:87], 0
    v_mfma_f32_16x16x32_bf16 v[136:139], v[208:211], v[84:87], 0
    s_nop 1
    v_mov_b32_dpp v15, v56 quad_perm:[0,1,2,3] row_mask:0x1 bank_mask:0xf
    v_mfma_f32_16x16x32_bf16 v[140:143], v[224:227], v[84:87], 0
    v_mfma_f32_16x16x32_bf16 v[144:147], v[240:243], v[84:87], 0
    v_mfma_f32_16x16x32_bf16 v[68:71], v[88:91], v[88:91], v[68:71]
    v_mfma_f32_16x16x32_bf16 v[132:135], v[196:199], v[88:91], v[132:135]
    v_mfma_f32_16x16x32_bf16 v[136:139], v[212:215], v[88:91], v[136:139]
    v_mfma_f32_16x16x32_bf16 v[140:143], v[228:231], v[88:91], v[140:143]
    v_mfma_f32_16x16x32_bf16 v[144:147], v[244:247], v[88:91], v[144:147]
    v_mfma_f32_16x16x32_bf16 v[68:71], v[92:95], v[92:95], v[68:71]
    v_mfma_f32_16x16x32_bf16 v[132:135], v[200:203], v[92:95], v[132:135]
    v_mfma_f32_16x16x32_bf16 v[136:139], v[216:219], v[92:95], v[136:139]
    v_mfma_f32_16x16x32_bf16 v[140:143], v[232:235], v[92:95], v[140:143]
    v_mfma_f32_16x16x32_bf16 v[144:147], v[248:251], v[92:95], v[144:147]
    v_mfma_f32_16x16x32_bf16 v[68:71], v[96:99], v[96:99], v[68:71]
    v_mfma_f32_16x16x32_bf16 v[132:135], v[204:207], v[96:99], v[132:135]
    v_mfma_f32_16x16x32_bf16 v[136:139], v[220:223], v[96:99], v[136:139]
    v_mfma_f32_16x16x32_bf16 v[140:143], v[236:239], v[96:99], v[140:143]
    v_mfma_f32_16x16x32_bf16 v[144:147], v[252:255], v[96:99], v[144:147]
    s_nop 7
L_kpoll6:
    ds_read_b32 v183, v12
    s_waitcnt lgkmcnt(0)
    v_readfirstlane_b32 s52, v183
    s_nop 3
    s_cmp_gt_u32 s52, 7
    s_nop 0
    s_cbranch_scc1 L_kready6
    s_sleep 1
    s_add_u32 s58, s58, 1
    s_cmp_lt_u32 s58, 524288
    s_nop 0
    s_cbranch_scc1 L_kpoll6
L_kready6:
    ds_read2st64_b64 v[148:151], v4 offset0:48 offset1:48
    ds_read2st64_b64 v[152:155], v8 offset0:48 offset1:48
    ds_read2st64_b64 v[156:159], v5 offset0:48 offset1:48
    ds_read2st64_b64 v[160:163], v9 offset0:48 offset1:48
    ds_read2st64_b64 v[164:167], v6 offset0:48 offset1:48
    ds_read2st64_b64 v[168:171], v10 offset0:48 offset1:48
    ds_read2st64_b64 v[172:175], v7 offset0:48 offset1:48
    ds_read2st64_b64 v[176:179], v11 offset0:48 offset1:48
    s_waitcnt lgkmcnt(0)
    v_mfma_f32_16x16x32_bf16 v[72:75], v[28:31], v[148:151], 0
    v_cvt_pk_bf16_f32 v52, v68, v69
    v_cvt_pk_bf16_f32 v53, v70, v71
    v_and_b32 v52, v52, v20
    v_mfma_f32_16x16x32_bf16 v[76:79], v[28:31], v[152:155], 0
    v_and_b32 v53, v53, v21
    v_cvt_pk_bf16_f32 v40, v132, v133
    v_cvt_pk_bf16_f32 v41, v134, v135
    v_mfma_f32_16x16x16_bf16 v[48:51], v[22:23], v[52:53], 0
    v_cvt_pk_bf16_f32 v42, v136, v137
    v_cvt_pk_bf16_f32 v43, v138, v139
    v_cvt_pk_bf16_f32 v44, v140, v141
    v_cvt_pk_bf16_f32 v45, v142, v143
    v_cvt_pk_bf16_f32 v46, v144, v145
    v_cvt_pk_bf16_f32 v47, v146, v147
    v_mfma_f32_16x16x16_bf16 v[100:103], v[24:25], v[40:41], v[48:51]
    v_cvt_pk_bf16_f32 v84, v72, v73
    v_cvt_pk_bf16_f32 v85, v74, v75
    v_cvt_pk_bf16_f32 v86, v76, v77
    v_mfma_f32_16x16x16_bf16 v[104:107], v[24:25], v[42:43], v[48:51]
    v_cvt_pk_bf16_f32 v87, v78, v79
    v_mfma_f32_16x16x32_bf16 v[80:83], v[28:31], v[156:159], 0
    s_nop 1
    v_cvt_pk_bf16_f32 v40, v100, v101
    v_mfma_f32_16x16x16_bf16 v[108:111], v[24:25], v[44:45], v[48:51]
    v_cvt_pk_bf16_f32 v41, v102, v103
    v_lshlrev_b32 v132, 16, v40
    v_cvt_pk_bf16_f32 v42, v104, v105
    v_mfma_f32_16x16x16_bf16 v[112:115], v[24:25], v[46:47], v[48:51]
    v_cvt_pk_bf16_f32 v43, v106, v107
    v_and_b32 v133, v26, v40
    v_lshlrev_b32 v134, 16, v41
    v_mfma_f32_16x16x32_bf16 v[72:75], v[28:31], v[160:163], 0
    v_and_b32 v135, v26, v41
    v_lshlrev_b32 v136, 16, v42
    v_and_b32 v137, v26, v42
    v_mfma_f32_16x16x32_bf16 v[76:79], v[28:31], v[164:167], 0
    v_lshlrev_b32 v138, 16, v43
    v_and_b32 v139, v26, v43
    v_cvt_pk_bf16_f32 v88, v80, v81
    v_cvt_pk_bf16_f32 v89, v82, v83
    v_mul_f32 v132, v27, v132
    v_mul_f32 v133, v27, v133
    v_mul_f32 v134, v27, v134
    v_mul_f32 v135, v27, v135
    v_mul_f32 v136, v27, v136
    v_mul_f32 v137, v27, v137
    v_mul_f32 v138, v27, v138
    v_mul_f32 v139, v27, v139
    v_mfma_f32_16x16x32_bf16 v[80:83], v[28:31], v[168:171], 0
    v_cvt_pk_bf16_f32 v44, v108, v109
    v_cvt_pk_bf16_f32 v45, v110, v111
    v_cvt_pk_bf16_f32 v46, v112, v113
    v_cvt_pk_bf16_f32 v47, v114, v115
    v_exp_f32 v132, v132
    v_exp_f32 v133, v133
    v_exp_f32 v134, v134
    v_exp_f32 v135, v135
    v_exp_f32 v136, v136
    v_exp_f32 v137, v137
    v_exp_f32 v138, v138
    v_exp_f32 v139, v139
    v_lshlrev_b32 v140, 16, v44
    v_and_b32 v141, v26, v44
    v_lshlrev_b32 v142, 16, v45
    v_and_b32 v143, v26, v45
    v_lshlrev_b32 v144, 16, v46
    v_and_b32 v145, v26, v46
    v_lshlrev_b32 v146, 16, v47
    v_and_b32 v147, v26, v47
    v_cvt_pk_bf16_f32 v40, v132, v133
    v_cvt_pk_bf16_f32 v41, v134, v135
    v_cvt_pk_bf16_f32 v42, v136, v137
    v_cvt_pk_bf16_f32 v43, v138, v139
    v_cvt_pk_bf16_f32 v90, v72, v73
    v_cvt_pk_bf16_f32 v91, v74, v75
    v_cvt_pk_bf16_f32 v92, v76, v77
    v_cvt_pk_bf16_f32 v93, v78, v79
    v_mul_f32 v140, v27, v140
    v_mul_f32 v141, v27, v141
    v_mul_f32 v142, v27, v142
    v_mul_f32 v143, v27, v143
    v_mul_f32 v144, v27, v144
    v_mul_f32 v145, v27, v145
    v_mul_f32 v146, v27, v146
    v_mul_f32 v147, v27, v147
    v_mfma_f32_16x16x32_bf16 v[72:75], v[28:31], v[172:175], 0
    v_exp_f32 v140, v140
    v_exp_f32 v141, v141
    v_exp_f32 v142, v142
    v_mfma_f32_16x16x32_bf16 v[76:79], v[28:31], v[176:179], 0
    v_exp_f32 v143, v143
    v_exp_f32 v144, v144
    v_exp_f32 v145, v145
    v_exp_f32 v146, v146
    v_exp_f32 v147, v147
    v_cvt_pk_bf16_f32 v44, v140, v141
    v_cvt_pk_bf16_f32 v45, v142, v143
    v_cvt_pk_bf16_f32 v46, v144, v145
    v_cvt_pk_bf16_f32 v47, v146, v147
    v_mfma_f32_16x16x32_bf16 v[60:63], v[32:35], v[40:43], v[16:19]
    v_cvt_pk_bf16_f32 v94, v80, v81
    v_cvt_pk_bf16_f32 v95, v82, v83
    v_cvt_pk_bf16_f32 v96, v72, v73
    v_mfma_f32_16x16x32_bf16 v[60:63], v[36:39], v[44:47], v[60:63]
    v_cvt_pk_bf16_f32 v97, v74, v75
    v_cvt_pk_bf16_f32 v98, v76, v77
    v_cvt_pk_bf16_f32 v99, v78, v79
    v_mfma_f32_16x16x32_bf16 v[64:67], v[84:87], v[84:87], 0
    v_mfma_f32_16x16x32_bf16 v[116:119], v[192:195], v[84:87], 0
    v_mfma_f32_16x16x32_bf16 v[120:123], v[208:211], v[84:87], 0
    s_nop 1
    v_mov_b32_dpp v15, v60 quad_perm:[0,1,2,3] row_mask:0x2 bank_mask:0xf
    v_mfma_f32_16x16x32_bf16 v[124:127], v[224:227], v[84:87], 0
    v_mfma_f32_16x16x32_bf16 v[128:131], v[240:243], v[84:87], 0
    v_mfma_f32_16x16x32_bf16 v[64:67], v[88:91], v[88:91], v[64:67]
    v_mfma_f32_16x16x32_bf16 v[116:119], v[196:199], v[88:91], v[116:119]
    v_mfma_f32_16x16x32_bf16 v[120:123], v[212:215], v[88:91], v[120:123]
    v_mfma_f32_16x16x32_bf16 v[124:127], v[228:231], v[88:91], v[124:127]
    v_mfma_f32_16x16x32_bf16 v[128:131], v[244:247], v[88:91], v[128:131]
    v_mfma_f32_16x16x32_bf16 v[64:67], v[92:95], v[92:95], v[64:67]
    v_mfma_f32_16x16x32_bf16 v[116:119], v[200:203], v[92:95], v[116:119]
    v_mfma_f32_16x16x32_bf16 v[120:123], v[216:219], v[92:95], v[120:123]
    v_mfma_f32_16x16x32_bf16 v[124:127], v[232:235], v[92:95], v[124:127]
    v_mfma_f32_16x16x32_bf16 v[128:131], v[248:251], v[92:95], v[128:131]
    v_mfma_f32_16x16x32_bf16 v[64:67], v[96:99], v[96:99], v[64:67]
    v_mfma_f32_16x16x32_bf16 v[116:119], v[204:207], v[96:99], v[116:119]
    v_mfma_f32_16x16x32_bf16 v[120:123], v[220:223], v[96:99], v[120:123]
    v_mfma_f32_16x16x32_bf16 v[124:127], v[236:239], v[96:99], v[124:127]
    v_mfma_f32_16x16x32_bf16 v[128:131], v[252:255], v[96:99], v[128:131]
    s_nop 7
L_kpoll7:
    ds_read_b32 v183, v12
    s_waitcnt lgkmcnt(0)
    v_readfirstlane_b32 s52, v183
    s_nop 3
    s_cmp_gt_u32 s52, 8
    s_nop 0
    s_cbranch_scc1 L_kready7
    s_sleep 1
    s_add_u32 s58, s58, 1
    s_cmp_lt_u32 s58, 524288
    s_nop 0
    s_cbranch_scc1 L_kpoll7
L_kready7:
    ds_read2st64_b64 v[148:151], v4 offset0:56 offset1:56
    ds_read2st64_b64 v[152:155], v8 offset0:56 offset1:56
    ds_read2st64_b64 v[156:159], v5 offset0:56 offset1:56
    ds_read2st64_b64 v[160:163], v9 offset0:56 offset1:56
    ds_read2st64_b64 v[164:167], v6 offset0:56 offset1:56
    ds_read2st64_b64 v[168:171], v10 offset0:56 offset1:56
    ds_read2st64_b64 v[172:175], v7 offset0:56 offset1:56
    ds_read2st64_b64 v[176:179], v11 offset0:56 offset1:56
    s_waitcnt lgkmcnt(0)
    v_mfma_f32_16x16x32_bf16 v[72:75], v[28:31], v[148:151], 0
    v_cvt_pk_bf16_f32 v52, v64, v65
    v_cvt_pk_bf16_f32 v53, v66, v67
    v_and_b32 v52, v52, v20
    v_mfma_f32_16x16x32_bf16 v[76:79], v[28:31], v[152:155], 0
    v_and_b32 v53, v53, v21
    v_cvt_pk_bf16_f32 v40, v116, v117
    v_cvt_pk_bf16_f32 v41, v118, v119
    v_mfma_f32_16x16x16_bf16 v[48:51], v[22:23], v[52:53], 0
    v_cvt_pk_bf16_f32 v42, v120, v121
    v_cvt_pk_bf16_f32 v43, v122, v123
    v_cvt_pk_bf16_f32 v44, v124, v125
    v_cvt_pk_bf16_f32 v45, v126, v127
    v_cvt_pk_bf16_f32 v46, v128, v129
    v_cvt_pk_bf16_f32 v47, v130, v131
    v_mfma_f32_16x16x16_bf16 v[100:103], v[24:25], v[40:41], v[48:51]
    v_cvt_pk_bf16_f32 v84, v72, v73
    v_cvt_pk_bf16_f32 v85, v74, v75
    v_cvt_pk_bf16_f32 v86, v76, v77
    v_mfma_f32_16x16x16_bf16 v[104:107], v[24:25], v[42:43], v[48:51]
    v_cvt_pk_bf16_f32 v87, v78, v79
    v_mfma_f32_16x16x32_bf16 v[80:83], v[28:31], v[156:159], 0
    s_nop 1
    v_cvt_pk_bf16_f32 v40, v100, v101
    v_mfma_f32_16x16x16_bf16 v[108:111], v[24:25], v[44:45], v[48:51]
    v_cvt_pk_bf16_f32 v41, v102, v103
    v_lshlrev_b32 v116, 16, v40
    v_cvt_pk_bf16_f32 v42, v104, v105
    v_mfma_f32_16x16x16_bf16 v[112:115], v[24:25], v[46:47], v[48:51]
    v_cvt_pk_bf16_f32 v43, v106, v107
    v_and_b32 v117, v26, v40
    v_lshlrev_b32 v118, 16, v41
    v_mfma_f32_16x16x32_bf16 v[72:75], v[28:31], v[160:163], 0
    v_and_b32 v119, v26, v41
    v_lshlrev_b32 v120, 16, v42
    v_and_b32 v121, v26, v42
    v_mfma_f32_16x16x32_bf16 v[76:79], v[28:31], v[164:167], 0
    v_lshlrev_b32 v122, 16, v43
    v_and_b32 v123, v26, v43
    v_cvt_pk_bf16_f32 v88, v80, v81
    v_cvt_pk_bf16_f32 v89, v82, v83
    v_mul_f32 v116, v27, v116
    v_mul_f32 v117, v27, v117
    v_mul_f32 v118, v27, v118
    v_mul_f32 v119, v27, v119
    v_mul_f32 v120, v27, v120
    v_mul_f32 v121, v27, v121
    v_mul_f32 v122, v27, v122
    v_mul_f32 v123, v27, v123
    v_mfma_f32_16x16x32_bf16 v[80:83], v[28:31], v[168:171], 0
    v_cvt_pk_bf16_f32 v44, v108, v109
    v_cvt_pk_bf16_f32 v45, v110, v111
    v_cvt_pk_bf16_f32 v46, v112, v113
    v_cvt_pk_bf16_f32 v47, v114, v115
    v_exp_f32 v116, v116
    v_exp_f32 v117, v117
    v_exp_f32 v118, v118
    v_exp_f32 v119, v119
    v_exp_f32 v120, v120
    v_exp_f32 v121, v121
    v_exp_f32 v122, v122
    v_exp_f32 v123, v123
    v_lshlrev_b32 v124, 16, v44
    v_and_b32 v125, v26, v44
    v_lshlrev_b32 v126, 16, v45
    v_and_b32 v127, v26, v45
    v_lshlrev_b32 v128, 16, v46
    v_and_b32 v129, v26, v46
    v_lshlrev_b32 v130, 16, v47
    v_and_b32 v131, v26, v47
    v_cvt_pk_bf16_f32 v40, v116, v117
    v_cvt_pk_bf16_f32 v41, v118, v119
    v_cvt_pk_bf16_f32 v42, v120, v121
    v_cvt_pk_bf16_f32 v43, v122, v123
    v_cvt_pk_bf16_f32 v90, v72, v73
    v_cvt_pk_bf16_f32 v91, v74, v75
    v_cvt_pk_bf16_f32 v92, v76, v77
    v_cvt_pk_bf16_f32 v93, v78, v79
    v_mul_f32 v124, v27, v124
    v_mul_f32 v125, v27, v125
    v_mul_f32 v126, v27, v126
    v_mul_f32 v127, v27, v127
    v_mul_f32 v128, v27, v128
    v_mul_f32 v129, v27, v129
    v_mul_f32 v130, v27, v130
    v_mul_f32 v131, v27, v131
    v_mfma_f32_16x16x32_bf16 v[72:75], v[28:31], v[172:175], 0
    v_exp_f32 v124, v124
    v_exp_f32 v125, v125
    v_exp_f32 v126, v126
    v_mfma_f32_16x16x32_bf16 v[76:79], v[28:31], v[176:179], 0
    v_exp_f32 v127, v127
    v_exp_f32 v128, v128
    v_exp_f32 v129, v129
    v_exp_f32 v130, v130
    v_exp_f32 v131, v131
    v_cvt_pk_bf16_f32 v44, v124, v125
    v_cvt_pk_bf16_f32 v45, v126, v127
    v_cvt_pk_bf16_f32 v46, v128, v129
    v_cvt_pk_bf16_f32 v47, v130, v131
    v_mfma_f32_16x16x32_bf16 v[56:59], v[32:35], v[40:43], v[16:19]
    v_cvt_pk_bf16_f32 v94, v80, v81
    v_cvt_pk_bf16_f32 v95, v82, v83
    v_cvt_pk_bf16_f32 v96, v72, v73
    v_mfma_f32_16x16x32_bf16 v[56:59], v[36:39], v[44:47], v[56:59]
    v_cvt_pk_bf16_f32 v97, v74, v75
    v_cvt_pk_bf16_f32 v98, v76, v77
    v_cvt_pk_bf16_f32 v99, v78, v79
    v_mfma_f32_16x16x32_bf16 v[68:71], v[84:87], v[84:87], 0
    v_mfma_f32_16x16x32_bf16 v[132:135], v[192:195], v[84:87], 0
    v_mfma_f32_16x16x32_bf16 v[136:139], v[208:211], v[84:87], 0
    s_nop 1
    v_mov_b32_dpp v15, v56 quad_perm:[0,1,2,3] row_mask:0x4 bank_mask:0xf
    v_mfma_f32_16x16x32_bf16 v[140:143], v[224:227], v[84:87], 0
    v_mfma_f32_16x16x32_bf16 v[144:147], v[240:243], v[84:87], 0
    v_mfma_f32_16x16x32_bf16 v[68:71], v[88:91], v[88:91], v[68:71]
    v_mfma_f32_16x16x32_bf16 v[132:135], v[196:199], v[88:91], v[132:135]
    v_mfma_f32_16x16x32_bf16 v[136:139], v[212:215], v[88:91], v[136:139]
    v_mfma_f32_16x16x32_bf16 v[140:143], v[228:231], v[88:91], v[140:143]
    v_mfma_f32_16x16x32_bf16 v[144:147], v[244:247], v[88:91], v[144:147]
    v_mfma_f32_16x16x32_bf16 v[68:71], v[92:95], v[92:95], v[68:71]
    v_mfma_f32_16x16x32_bf16 v[132:135], v[200:203], v[92:95], v[132:135]
    v_mfma_f32_16x16x32_bf16 v[136:139], v[216:219], v[92:95], v[136:139]
    v_mfma_f32_16x16x32_bf16 v[140:143], v[232:235], v[92:95], v[140:143]
    v_mfma_f32_16x16x32_bf16 v[144:147], v[248:251], v[92:95], v[144:147]
    v_mfma_f32_16x16x32_bf16 v[68:71], v[96:99], v[96:99], v[68:71]
    v_mfma_f32_16x16x32_bf16 v[132:135], v[204:207], v[96:99], v[132:135]
    v_mfma_f32_16x16x32_bf16 v[136:139], v[220:223], v[96:99], v[136:139]
    v_mfma_f32_16x16x32_bf16 v[140:143], v[236:239], v[96:99], v[140:143]
    v_mfma_f32_16x16x32_bf16 v[144:147], v[252:255], v[96:99], v[144:147]
    s_nop 3
    v_cvt_pk_bf16_f32 v52, v68, v69
    v_cvt_pk_bf16_f32 v53, v70, v71
    v_and_b32 v52, v52, v20
    v_and_b32 v53, v53, v21
    v_cvt_pk_bf16_f32 v40, v132, v133
    v_cvt_pk_bf16_f32 v41, v134, v135
    v_mfma_f32_16x16x16_bf16 v[48:51], v[22:23], v[52:53], 0
    v_cvt_pk_bf16_f32 v42, v136, v137
    v_cvt_pk_bf16_f32 v43, v138, v139
    v_cvt_pk_bf16_f32 v44, v140, v141
    v_cvt_pk_bf16_f32 v45, v142, v143
    v_cvt_pk_bf16_f32 v46, v144, v145
    v_cvt_pk_bf16_f32 v47, v146, v147
    v_mfma_f32_16x16x16_bf16 v[100:103], v[24:25], v[40:41], v[48:51]
    s_lshl_b32 s52, s56, 10
    s_add_u32 s52, s52, 151552
    v_lshl_add_u32 v182, v1, 3, s52
    v_mfma_f32_16x16x16_bf16 v[104:107], v[24:25], v[42:43], v[48:51]
    v_mfma_f32_16x16x16_bf16 v[108:111], v[24:25], v[44:45], v[48:51]
    v_mfma_f32_16x16x16_bf16 v[112:115], v[24:25], v[46:47], v[48:51]
    s_nop 1
    v_cvt_pk_bf16_f32 v40, v100, v101
    v_cvt_pk_bf16_f32 v41, v102, v103
    v_lshlrev_b32 v132, 16, v40
    v_and_b32 v133, v26, v40
    v_cvt_pk_bf16_f32 v42, v104, v105
    v_cvt_pk_bf16_f32 v43, v106, v107
    v_lshlrev_b32 v134, 16, v41
    v_and_b32 v135, v26, v41
    v_lshlrev_b32 v136, 16, v42
    v_and_b32 v137, v26, v42
    v_lshlrev_b32 v138, 16, v43
    v_and_b32 v139, v26, v43
    v_mul_f32 v132, v27, v132
    v_mul_f32 v133, v27, v133
    v_mul_f32 v134, v27, v134
    v_mul_f32 v135, v27, v135
    v_mul_f32 v136, v27, v136
    v_mul_f32 v137, v27, v137
    v_mul_f32 v138, v27, v138
    v_mul_f32 v139, v27, v139
    v_cvt_pk_bf16_f32 v44, v108, v109
    v_cvt_pk_bf16_f32 v45, v110, v111
    v_cvt_pk_bf16_f32 v46, v112, v113
    v_cvt_pk_bf16_f32 v47, v114, v115
    v_exp_f32 v132, v132
    v_exp_f32 v133, v133
    v_exp_f32 v134, v134
    v_exp_f32 v135, v135
    v_exp_f32 v136, v136
    v_exp_f32 v137, v137
    v_exp_f32 v138, v138
    v_exp_f32 v139, v139
    v_lshlrev_b32 v140, 16, v44
    v_and_b32 v141, v26, v44
    v_lshlrev_b32 v142, 16, v45
    v_and_b32 v143, v26, v45
    v_lshlrev_b32 v144, 16, v46
    v_and_b32 v145, v26, v46
    v_lshlrev_b32 v146, 16, v47
    v_and_b32 v147, v26, v47
    v_cvt_pk_bf16_f32 v40, v132, v133
    v_cvt_pk_bf16_f32 v41, v134, v135
    v_cvt_pk_bf16_f32 v42, v136, v137
    v_cvt_pk_bf16_f32 v43, v138, v139
    v_mul_f32 v140, v27, v140
    v_mul_f32 v141, v27, v141
    v_mul_f32 v142, v27, v142
    v_mul_f32 v143, v27, v143
    v_mul_f32 v144, v27, v144
    v_mul_f32 v145, v27, v145
    v_mul_f32 v146, v27, v146
    v_mul_f32 v147, v27, v147
    v_exp_f32 v140, v140
    v_exp_f32 v141, v141
    v_exp_f32 v142, v142
    v_exp_f32 v143, v143
    v_exp_f32 v144, v144
    v_exp_f32 v145, v145
    v_exp_f32 v146, v146
    v_exp_f32 v147, v147
    v_cvt_pk_bf16_f32 v44, v140, v141
    v_cvt_pk_bf16_f32 v45, v142, v143
    v_cvt_pk_bf16_f32 v46, v144, v145
    v_cvt_pk_bf16_f32 v47, v146, v147
    v_mfma_f32_16x16x32_bf16 v[60:63], v[32:35], v[40:43], v[16:19]
    v_cvt_pk_bf16_f32 v100, v14, v14
    v_and_b32 v52, v26, v100
    v_sub_f32 v52, v14, v52
    v_mfma_f32_16x16x32_bf16 v[60:63], v[36:39], v[44:47], v[60:63]
    v_cvt_pk_bf16_f32 v101, v52, v52
    ds_write_b64 v182, v[100:101]
    s_nop 5
    v_mov_b32_dpp v15, v60 quad_perm:[0,1,2,3] row_mask:0x8 bank_mask:0xf
    v_add_f32 v54, v14, v15
    v_cvt_pk_bf16_f32 v102, v15, v15
    v_and_b32 v53, v26, v102
    v_add_f32_dpp v54, v54, v54 row_ror:8 row_mask:0xf bank_mask:0xf
    v_sub_f32 v53, v15, v53
    v_cvt_pk_bf16_f32 v103, v53, v53
    v_add_f32_dpp v54, v54, v54 row_ror:4 row_mask:0xf bank_mask:0xf
    ds_write_b64 v182, v[102:103] offset:512
    s_lshl_b32 s53, s56, 4
    v_add_f32_dpp v54, v54, v54 row_ror:2 row_mask:0xf bank_mask:0xf
    s_add_u32 s53, s53, 155648
    v_lshl_add_u32 v55, v2, 2, s53
    v_add_f32_dpp v54, v54, v54 row_ror:1 row_mask:0xf bank_mask:0xf
    ds_write_b32 v55, v54
    s_waitcnt lgkmcnt(0)
    s_mov_b64 exec, 1
    v_mov_b32 v183, 1
    ds_write_b32 v12, v183 offset:8
    s_mov_b64 exec, -1
    s_cmp_ge_u32 s50, 6
    s_nop 0
    s_cbranch_scc1 L_idle
    v_subrev_u32 v4, 256, v0
    v_lshrrev_b32 v6, 5, v4
    v_and_b32 v10, 7, v4
    v_lshl_add_u32 v6, v6, 4, v10
    v_bfe_u32 v10, v4, 3, 2
    v_lshlrev_b32 v10, 2, v10
    v_lshl_add_u32 v5, v6, 4, v10
    v_add_u32 v5, 147456, v5
    v_lshlrev_b32 v6, 3, v4
    v_and_b32 v182, 3, v1
    v_lshlrev_b32 v182, 4, v182
    v_add_u32 v182, 155712, v182
    s_nop 1
L_denpoll:
    ds_read_b32 v183, v182 offset:8
    s_waitcnt lgkmcnt(0)
    v_cmp_ne_u32 vcc, 1, v183
    s_nop 4
    s_cbranch_vccz L_denready
    s_sleep 1
    s_add_u32 s58, s58, 1
    s_cmp_lt_u32 s58, 524288
    s_nop 0
    s_cbranch_scc1 L_denpoll
L_denready:
    v_mov_b32 v182, 155648
    ds_read_b128 v[116:119], v182
    ds_read_b128 v[120:123], v182 offset:16
    ds_read_b128 v[124:127], v182 offset:32
    ds_read_b128 v[128:131], v182 offset:48
    s_waitcnt lgkmcnt(0)
    v_add_f32 v116, v116, v124
    v_add_f32 v117, v117, v125
    v_add_f32 v118, v118, v126
    v_add_f32 v119, v119, v127
    v_add_f32 v120, v120, v128
    v_add_f32 v121, v121, v129
    v_add_f32 v122, v122, v130
    v_add_f32 v123, v123, v131
    v_add_f32 v116, v116, v120
    v_add_f32 v117, v117, v121
    v_add_f32 v118, v118, v122
    v_add_f32 v119, v119, v123
    v_add_f32 v116, v116, v118
    v_add_f32 v117, v117, v119
    v_add_f32 v8, v116, v117
    v_and_b32 v182, 3, v1
    v_lshlrev_b32 v182, 4, v182
    v_add_u32 v182, 155712, v182
    s_cmp_eq_u32 s49, 0
    s_nop 0
    s_cbranch_scc1 L_consumer
L_pvP:
    ds_read_b32 v183, v182 offset:12
    s_waitcnt lgkmcnt(0)
    v_cmp_ne_u32 vcc, 1, v183
    s_nop 4
    s_cbranch_vccz L_pvokP
    s_add_u32 s58, s58, 1
    s_cmp_lt_u32 s58, 1048576
    s_nop 0
    s_cbranch_scc1 L_pvP
L_pvokP:
    ds_read_b32 v116, v5
    ds_read_b32 v117, v5 offset:128
    ds_read_b32 v118, v5 offset:1024
    ds_read_b32 v119, v5 offset:1152
    ds_read_b32 v120, v5 offset:2048
    ds_read_b32 v121, v5 offset:2176
    ds_read_b32 v122, v5 offset:3072
    ds_read_b32 v123, v5 offset:3200
    s_waitcnt lgkmcnt(0)
    v_add_f32 v116, v116, v120
    v_add_f32 v117, v117, v121
    v_add_f32 v118, v118, v122
    v_add_f32 v119, v119, v123
    v_add_f32 v116, v116, v118
    v_add_f32 v117, v117, v119
    v_add_f32 v7, v116, v117
    v_min_u32 v116, -2, v7
    v_min_u32 v117, -2, v8
    buffer_store_dwordx2 v[116:117], v6, s[36:39], s61 offen sc1
    s_nop 0
    s_branch L_end_c
L_consumer:
    s_mov_b32 s53, 0
    s_lshl_b32 s52, s48, 2
    s_setprio 3
L_flagloop:
    buffer_load_dword v9, off, s[40:43], s52 sc1
    s_waitcnt vmcnt(0)
    v_cmp_gt_u32 vcc, 7, v9
    s_nop 4
    s_cbranch_vccz L_flagok
    s_add_u32 s53, s53, 1
    s_cmp_gt_u32 s53, 262144
    s_nop 0
    s_cbranch_scc0 L_flagloop
L_flagok:
    s_mov_b32 s53, 0
    s_mov_b32 s55, 0
    s_add_u32 s54, s61, 1024
    buffer_load_dwordx2 v[134:135], v6, s[36:39], s54 offen sc1
    s_add_u32 s54, s61, 2048
    buffer_load_dwordx2 v[136:137], v6, s[36:39], s54 offen sc1
    s_add_u32 s54, s61, 3072
    buffer_load_dwordx2 v[138:139], v6, s[36:39], s54 offen sc1
    s_add_u32 s54, s61, 4096
    buffer_load_dwordx2 v[140:141], v6, s[36:39], s54 offen sc1
    s_add_u32 s54, s61, 5120
    buffer_load_dwordx2 v[142:143], v6, s[36:39], s54 offen sc1
    s_add_u32 s54, s61, 6144
    buffer_load_dwordx2 v[144:145], v6, s[36:39], s54 offen sc1
    s_add_u32 s54, s61, 7168
    buffer_load_dwordx2 v[146:147], v6, s[36:39], s54 offen sc1
    s_sleep 6
    s_add_u32 s54, s61, 1024
    buffer_load_dwordx2 v[150:151], v6, s[36:39], s54 offen sc1
    s_add_u32 s54, s61, 2048
    buffer_load_dwordx2 v[152:153], v6, s[36:39], s54 offen sc1
    s_add_u32 s54, s61, 3072
    buffer_load_dwordx2 v[154:155], v6, s[36:39], s54 offen sc1
    s_add_u32 s54, s61, 4096
    buffer_load_dwordx2 v[156:157], v6, s[36:39], s54 offen sc1
    s_add_u32 s54, s61, 5120
    buffer_load_dwordx2 v[158:159], v6, s[36:39], s54 offen sc1
    s_add_u32 s54, s61, 6144
    buffer_load_dwordx2 v[160:161], v6, s[36:39], s54 offen sc1
    s_add_u32 s54, s61, 7168
    buffer_load_dwordx2 v[162:163], v6, s[36:39], s54 offen sc1
    s_sleep 6
    s_add_u32 s54, s61, 1024
    buffer_load_dwordx2 v[166:167], v6, s[36:39], s54 offen sc1
    s_add_u32 s54, s61, 2048
    buffer_load_dwordx2 v[168:169], v6, s[36:39], s54 offen sc1
    s_add_u32 s54, s61, 3072
    buffer_load_dwordx2 v[170:171], v6, s[36:39], s54 offen sc1
    s_add_u32 s54, s61, 4096
    buffer_load_dwordx2 v[172:173], v6, s[36:39], s54 offen sc1
    s_add_u32 s54, s61, 5120
    buffer_load_dwordx2 v[174:175], v6, s[36:39], s54 offen sc1
    s_add_u32 s54, s61, 6144
    buffer_load_dwordx2 v[176:177], v6, s[36:39], s54 offen sc1
    s_add_u32 s54, s61, 7168
    buffer_load_dwordx2 v[178:179], v6, s[36:39], s54 offen sc1
L_pollloop:
    s_waitcnt vmcnt(14)
    v_max3_u32 v10, v134, v135, v136
    v_max3_u32 v10, v10, v137, v138
    v_max3_u32 v10, v10, v139, v140
    v_max3_u32 v10, v10, v141, v142
    v_max3_u32 v10, v10, v143, v144
    v_max3_u32 v10, v10, v145, v146
    v_max_u32 v10, v10, v147
    v_cmp_eq_u32 vcc, -1, v10
    s_nop 4
    s_cbranch_vccz L_done0
    s_add_u32 s54, s61, 1024
    buffer_load_dwordx2 v[134:135], v6, s[36:39], s54 offen sc1
    s_add_u32 s54, s61, 2048
    buffer_load_dwordx2 v[136:137], v6, s[36:39], s54 offen sc1
    s_add_u32 s54, s61, 3072
    buffer_load_dwordx2 v[138:139], v6, s[36:39], s54 offen sc1
    s_add_u32 s54, s61, 4096
    buffer_load_dwordx2 v[140:141], v6, s[36:39], s54 offen sc1
    s_add_u32 s54, s61, 5120
    buffer_load_dwordx2 v[142:143], v6, s[36:39], s54 offen sc1
    s_add_u32 s54, s61, 6144
    buffer_load_dwordx2 v[144:145], v6, s[36:39], s54 offen sc1
    s_add_u32 s54, s61, 7168
    buffer_load_dwordx2 v[146:147], v6, s[36:39], s54 offen sc1
    s_cmp_lg_u32 s55, 0
    s_nop 0
    s_cbranch_scc1 L_nd0
    ds_read_b32 v183, v182 offset:12
    s_waitcnt lgkmcnt(0)
    v_cmp_ne_u32 vcc, 1, v183
    s_nop 4
    s_cbranch_vccnz L_nd0
    ds_read_b32 v116, v5
    ds_read_b32 v117, v5 offset:128
    ds_read_b32 v118, v5 offset:1024
    ds_read_b32 v119, v5 offset:1152
    ds_read_b32 v120, v5 offset:2048
    ds_read_b32 v121, v5 offset:2176
    ds_read_b32 v122, v5 offset:3072
    ds_read_b32 v123, v5 offset:3200
    s_waitcnt lgkmcnt(0)
    v_add_f32 v116, v116, v120
    v_add_f32 v117, v117, v121
    v_add_f32 v118, v118, v122
    v_add_f32 v119, v119, v123
    v_add_f32 v116, v116, v118
    v_add_f32 v117, v117, v119
    v_add_f32 v7, v116, v117
    s_mov_b32 s55, 1
    s_nop 0
L_nd0:
    s_waitcnt vmcnt(14)
    v_max3_u32 v10, v150, v151, v152
    v_max3_u32 v10, v10, v153, v154
    v_max3_u32 v10, v10, v155, v156
    v_max3_u32 v10, v10, v157, v158
    v_max3_u32 v10, v10, v159, v160
    v_max3_u32 v10, v10, v161, v162
    v_max_u32 v10, v10, v163
    v_cmp_eq_u32 vcc, -1, v10
    s_nop 4
    s_cbranch_vccz L_done1
    s_add_u32 s54, s61, 1024
    buffer_load_dwordx2 v[150:151], v6, s[36:39], s54 offen sc1
    s_add_u32 s54, s61, 2048
    buffer_load_dwordx2 v[152:153], v6, s[36:39], s54 offen sc1
    s_add_u32 s54, s61, 3072
    buffer_load_dwordx2 v[154:155], v6, s[36:39], s54 offen sc1
    s_add_u32 s54, s61, 4096
    buffer_load_dwordx2 v[156:157], v6, s[36:39], s54 offen sc1
    s_add_u32 s54, s61, 5120
    buffer_load_dwordx2 v[158:159], v6, s[36:39], s54 offen sc1
    s_add_u32 s54, s61, 6144
    buffer_load_dwordx2 v[160:161], v6, s[36:39], s54 offen sc1
    s_add_u32 s54, s61, 7168
    buffer_load_dwordx2 v[162:163], v6, s[36:39], s54 offen sc1
    s_cmp_lg_u32 s55, 0
    s_nop 0
    s_cbranch_scc1 L_nd1
    ds_read_b32 v183, v182 offset:12
    s_waitcnt lgkmcnt(0)
    v_cmp_ne_u32 vcc, 1, v183
    s_nop 4
    s_cbranch_vccnz L_nd1
    ds_read_b32 v116, v5
    ds_read_b32 v117, v5 offset:128
    ds_read_b32 v118, v5 offset:1024
    ds_read_b32 v119, v5 offset:1152
    ds_read_b32 v120, v5 offset:2048
    ds_read_b32 v121, v5 offset:2176
    ds_read_b32 v122, v5 offset:3072
    ds_read_b32 v123, v5 offset:3200
    s_waitcnt lgkmcnt(0)
    v_add_f32 v116, v116, v120
    v_add_f32 v117, v117, v121
    v_add_f32 v118, v118, v122
    v_add_f32 v119, v119, v123
    v_add_f32 v116, v116, v118
    v_add_f32 v117, v117, v119
    v_add_f32 v7, v116, v117
    s_mov_b32 s55, 1
    s_nop 0
L_nd1:
    s_waitcnt vmcnt(14)
    v_max3_u32 v10, v166, v167, v168
    v_max3_u32 v10, v10, v169, v170
    v_max3_u32 v10, v10, v171, v172
    v_max3_u32 v10, v10, v173, v174
    v_max3_u32 v10, v10, v175, v176
    v_max3_u32 v10, v10, v177, v178
    v_max_u32 v10, v10, v179
    v_cmp_eq_u32 vcc, -1, v10
    s_nop 4
    s_cbranch_vccz L_done2
    s_add_u32 s54, s61, 1024
    buffer_load_dwordx2 v[166:167], v6, s[36:39], s54 offen sc1
    s_add_u32 s54, s61, 2048
    buffer_load_dwordx2 v[168:169], v6, s[36:39], s54 offen sc1
    s_add_u32 s54, s61, 3072
    buffer_load_dwordx2 v[170:171], v6, s[36:39], s54 offen sc1
    s_add_u32 s54, s61, 4096
    buffer_load_dwordx2 v[172:173], v6, s[36:39], s54 offen sc1
    s_add_u32 s54, s61, 5120
    buffer_load_dwordx2 v[174:175], v6, s[36:39], s54 offen sc1
    s_add_u32 s54, s61, 6144
    buffer_load_dwordx2 v[176:177], v6, s[36:39], s54 offen sc1
    s_add_u32 s54, s61, 7168
    buffer_load_dwordx2 v[178:179], v6, s[36:39], s54 offen sc1
    s_cmp_lg_u32 s55, 0
    s_nop 0
    s_cbranch_scc1 L_nd2
    ds_read_b32 v183, v182 offset:12
    s_waitcnt lgkmcnt(0)
    v_cmp_ne_u32 vcc, 1, v183
    s_nop 4
    s_cbranch_vccnz L_nd2
    ds_read_b32 v116, v5
    ds_read_b32 v117, v5 offset:128
    ds_read_b32 v118, v5 offset:1024
    ds_read_b32 v119, v5 offset:1152
    ds_read_b32 v120, v5 offset:2048
    ds_read_b32 v121, v5 offset:2176
    ds_read_b32 v122, v5 offset:3072
    ds_read_b32 v123, v5 offset:3200
    s_waitcnt lgkmcnt(0)
    v_add_f32 v116, v116, v120
    v_add_f32 v117, v117, v121
    v_add_f32 v118, v118, v122
    v_add_f32 v119, v119, v123
    v_add_f32 v116, v116, v118
    v_add_f32 v117, v117, v119
    v_add_f32 v7, v116, v117
    s_mov_b32 s55, 1
    s_nop 0
L_nd2:
    s_add_u32 s53, s53, 1
    s_cmp_gt_u32 s53, 131072
    s_nop 0
    s_cbranch_scc0 L_pollloop
L_done0:
    v_add_f32 v11, v134, v136
    v_add_f32 v8, v8, v135
    v_add_f32 v8, v8, v137
    v_add_f32 v11, v11, v138
    v_add_f32 v8, v8, v139
    v_add_f32 v11, v11, v140
    v_add_f32 v8, v8, v141
    v_add_f32 v11, v11, v142
    v_add_f32 v8, v8, v143
    v_add_f32 v11, v11, v144
    v_add_f32 v8, v8, v145
    v_add_f32 v11, v11, v146
    v_add_f32 v8, v8, v147
    s_nop 1
    s_branch L_fin
L_done1:
    v_add_f32 v11, v150, v152
    v_add_f32 v8, v8, v151
    v_add_f32 v8, v8, v153
    v_add_f32 v11, v11, v154
    v_add_f32 v8, v8, v155
    v_add_f32 v11, v11, v156
    v_add_f32 v8, v8, v157
    v_add_f32 v11, v11, v158
    v_add_f32 v8, v8, v159
    v_add_f32 v11, v11, v160
    v_add_f32 v8, v8, v161
    v_add_f32 v11, v11, v162
    v_add_f32 v8, v8, v163
    s_nop 1
    s_branch L_fin
L_done2:
    v_add_f32 v11, v166, v168
    v_add_f32 v8, v8, v167
    v_add_f32 v8, v8, v169
    v_add_f32 v11, v11, v170
    v_add_f32 v8, v8, v171
    v_add_f32 v11, v11, v172
    v_add_f32 v8, v8, v173
    v_add_f32 v11, v11, v174
    v_add_f32 v8, v8, v175
    v_add_f32 v11, v11, v176
    v_add_f32 v8, v8, v177
    v_add_f32 v11, v11, v178
    v_add_f32 v8, v8, v179
    s_nop 1
L_fin:
    s_cmp_lg_u32 s55, 0
    s_nop 0
    s_cbranch_scc1 L_fin2
L_pvC:
    ds_read_b32 v183, v182 offset:12
    s_waitcnt lgkmcnt(0)
    v_cmp_ne_u32 vcc, 1, v183
    s_nop 4
    s_cbranch_vccz L_pvokC
    s_add_u32 s58, s58, 1
    s_cmp_lt_u32 s58, 1048576
    s_nop 0
    s_cbranch_scc1 L_pvC
L_pvokC:
    ds_read_b32 v116, v5
    ds_read_b32 v117, v5 offset:128
    ds_read_b32 v118, v5 offset:1024
    ds_read_b32 v119, v5 offset:1152
    ds_read_b32 v120, v5 offset:2048
    ds_read_b32 v121, v5 offset:2176
    ds_read_b32 v122, v5 offset:3072
    ds_read_b32 v123, v5 offset:3200
    s_waitcnt lgkmcnt(0)
    v_add_f32 v116, v116, v120
    v_add_f32 v117, v117, v121
    v_add_f32 v118, v118, v122
    v_add_f32 v119, v119, v123
    v_add_f32 v116, v116, v118
    v_add_f32 v117, v117, v119
    v_add_f32 v7, v116, v117
    s_nop 1
L_fin2:
    v_add_f32 v7, v7, v11
    v_add_f32 v8, 0x35860000, v8
    v_rcp_f32 v10, v8
    s_nop 0
    v_mul_f32 v7, v7, v10
    v_cvt_pk_bf16_f32 v7, v7, v7
    s_lshl_b32 s52, s48, 8
    v_lshlrev_b32 v10, 1, v4
    buffer_store_short v7, v10, s[44:47], s52 offen
    s_nop 0
    s_branch L_end_c
L_idle:
L_end_c:
L_end_l:
L_end:
    s_endpgm
.section .rodata,"a"
.p2align 6
.amdhsa_kernel standalone__linear_kernel_rfa__decode_kernel
  .amdhsa_next_free_vgpr 256
  .amdhsa_next_free_sgpr 102
  .amdhsa_accum_offset 256
  .amdhsa_group_segment_fixed_size 0
  .amdhsa_kernarg_size 56
  .amdhsa_user_sgpr_count 2
  .amdhsa_user_sgpr_kernarg_segment_ptr 1
  .amdhsa_system_sgpr_workgroup_id_x 1
  .amdhsa_float_denorm_mode_32 3
.end_amdhsa_kernel
```
